```python
import torch

def _softmax(x, axis=-1):
    return torch.softmax(x, dim=axis)

def _gelu(x):
    return torch.nn.functional.gelu(x, approximate='tanh')

def _silu(x):
    return torch.nn.functional.silu(x)

def _sigmoid(x):
    return torch.sigmoid(x)

def _layernorm(x, axis=-1, eps=1e-05):
    m = x.mean(dim=axis, keepdim=True)
    v = x.var(dim=axis, keepdim=True, unbiased=False)
    return (x - m) / torch.sqrt(v + eps)

def _scatter_add(tgt, idx, src, axis=0):
    return tgt.clone().index_add_(axis, idx, src)

def _segment_sum(src, seg, n):
    out = torch.zeros((n,) + src.shape[1:], dtype=src.dtype)
    return out.index_add_(0, seg, src)

def _pad(x, pw):
    flat = tuple((v for pair in reversed(pw) for v in pair))
    return torch.nn.functional.pad(x, flat)
kernel_name = 'gated_mix__grouped_kv_mqa__mixer_gmlp__prompt'

def setup_inputs():

    _w = lambda a: (lambda t: t.to(torch.bfloat16) if t.is_floating_point() else t)(torch.as_tensor(a))

    def _A_setup():
        B, S, D, H = (1, 2048, 1024, 32)
        Dh = D // H
        return {'x': _w((lambda *s: torch.randn(*s, dtype=torch.bfloat16) * 0.05)(B, S, D)), 'wq': _w((lambda *s: torch.randn(*s, dtype=torch.bfloat16) * 0.8)(D, H * Dh)), 'wk': _w((lambda *s: torch.randn(*s, dtype=torch.bfloat16) * 0.8)(D, Dh)), 'wv': _w((lambda *s: torch.randn(*s, dtype=torch.bfloat16) * 0.2)(D, Dh)), 'wo': _w((lambda *s: torch.randn(*s, dtype=torch.bfloat16) * 0.2)(H * Dh, D))}
    _A_in = _A_setup()

    def _B_setup():
        B, S, D, F = (1, 2048, 1024, 3584)
        Fh = F // 2
        return {'x': _w((lambda *s: torch.randn(*s, dtype=torch.bfloat16) * 0.05)(B, S, D)), 'w_in': _w((lambda *s: torch.randn(*s, dtype=torch.bfloat16) * 0.4)(D, 2 * Fh)), 'w_sp': _w(0.01 * (lambda *s: torch.randn(*s, dtype=torch.bfloat16) * 0.4)(S, S)), 'b_sp': _w(1.0 + 0.01 * (lambda *s: torch.randn(*s, dtype=torch.bfloat16) * 0.05)(S)), 'w_out': _w((lambda *s: torch.randn(*s, dtype=torch.bfloat16) * 0.05)(Fh, D))}
    _B_in = _B_setup()
    return {'A_x': _A_in['x'], 'A_wq': _A_in['wq'], 'A_wk': _A_in['wk'], 'A_wv': _A_in['wv'], 'A_wo': _A_in['wo'], 'B_x': _B_in['x'], 'B_w_in': _B_in['w_in'], 'B_w_sp': _B_in['w_sp'], 'B_b_sp': _B_in['b_sp'], 'B_w_out': _B_in['w_out'], 'gate_w': _w((lambda *s: torch.randn(*s, dtype=torch.bfloat16) * 0.05)(1024) * 16.0)}

def reference(A_x, A_wq, A_wk, A_wv, A_wo, B_x, B_w_in, B_w_sp, B_b_sp, B_w_out, gate_w):

    def _A_ref(x, wq, wk, wv, wo):
        B, S, D = x.shape
        H = 32
        Dh = D // H
        q = (lambda x, *d: x.permute(*d))((x @ wq).reshape(B, S, H, Dh), 0, 2, 1, 3)
        k = x @ wk
        v = x @ wv
        scores = torch.einsum('bhqd,bkd->bhqk', q, k) * Dh ** (-0.5)
        p = _softmax(scores, axis=-1)
        o = torch.einsum('bhqk,bkd->bhqd', p, v)
        return (lambda x, *d: x.permute(*d))(o, 0, 2, 1, 3).reshape(B, S, H * Dh) @ wo

    def _B_ref(x, w_in, w_sp, b_sp, w_out):
        B, S, D = x.shape
        F = w_in.shape[-1]
        Fh = F // 2
        z = _gelu(torch.einsum('bsd,df->bsf', x, w_in))
        z1 = z[..., :Fh].clone()
        z2 = _layernorm(z[..., Fh:], axis=-1)
        g = torch.einsum('ts,bsf->btf', w_sp, z2) + b_sp[None, :, None]
        return torch.einsum('bsf,fd->bsd', z1 * g, w_out)
    x = A_x
    g = _sigmoid((x * gate_w).sum(-1, keepdims=True))
    a = _A_ref(x, A_wq, A_wk, A_wv, A_wo)
    b = _B_ref(x, B_w_in, B_w_sp, B_b_sp, B_w_out)
    return g * a + (1 - g) * b
```

```asm
; @launch grid=(256,1,1) block=(512,1,1) lds=159744
.amdgcn_target "amdgcn-amd-amdhsa--gfx950"
.text
.globl gated_mix__grouped_kv_mqa__mixer_gmlp__prompt_kernel
.p2align 8
.type gated_mix__grouped_kv_mqa__mixer_gmlp__prompt_kernel,@function
gated_mix__grouped_kv_mqa__mixer_gmlp__prompt_kernel:
    s_cmp_ge_u32 s2, 256
    s_cbranch_scc1 F_exit
    s_load_dwordx8 s[56:63], s[0:1], 0
    s_load_dwordx2 s[64:65], s[0:1], 32
    s_load_dwordx16 s[84:99], s[0:1], 48
    v_lshrrev_b32 v1, 6, v0
    v_and_b32 v0, 63, v0
    v_readfirstlane_b32 s5, v1
    s_getpc_b64 s[66:67]
F_pc0:
    s_cmp_lg_u32 s5, 0
    s_cbranch_scc1 F_nopc
    s_bfe_u32 s6, s2, 0x30003
    s_lshl_b32 s6, s6, 13
    v_lshl_add_u32 v2, v0, 7, s6
    v_min_u32 v2, F_exit-F_pc0, v2
    global_load_dword v211, v2, s[66:67]
F_nopc:
    s_and_b32 s3, s2, 1
    s_lshl_b32 s3, s3, 3
    s_lshr_b32 s6, s2, 5
    s_add_u32 s3, s3, s6
    s_bfe_u32 s4, s2, 0x20001
    s_lshl_b32 s4, s4, 2
    s_bfe_u32 s6, s2, 0x20003
    s_add_u32 s4, s4, s6
    s_and_b32 s78, s2, 3
    s_lshl_b32 s78, s78, 2
    s_lshr_b32 s6, s2, 6
    s_add_u32 s78, s78, s6
    s_bfe_u32 s79, s2, 0x10002
    s_lshl_b32 s79, s79, 3
    s_bfe_u32 s6, s2, 0x30003
    s_add_u32 s79, s79, s6
    s_mov_b32 s10, 4194304
    s_mov_b32 s11, 0x00020000
    s_mov_b32 s14, 2097152
    s_mov_b32 s15, 0x00020000
    s_mov_b32 s18, 7340032
    s_mov_b32 s19, 0x00020000
    s_mov_b32 s22, 65536
    s_mov_b32 s23, 0x00020000
    s_mov_b32 s26, 268435456
    s_mov_b32 s27, 0x00020000
    s_mov_b32 s30, 8388608
    s_mov_b32 s31, 0x00020000
    s_mov_b32 s34, 4096
    s_mov_b32 s35, 0x00020000
    s_mov_b32 s38, 2048
    s_mov_b32 s39, 0x00020000
    s_mov_b32 s42, 2097152
    s_mov_b32 s43, 0x00020000
    s_mov_b32 s46, 3670016
    s_mov_b32 s47, 0x00020000
    s_mov_b32 s50, 4194304
    s_mov_b32 s51, 0x00020000
    s_mov_b32 s54, 256
    s_mov_b32 s55, 0x00020000
    s_waitcnt lgkmcnt(0)
    s_bitcmp1_b32 s4, 1
    s_cselect_b64 s[60:61], s[62:63], s[60:61]
    s_mov_b64 s[8:9], s[56:57]
    s_mov_b64 s[12:13], s[58:59]
    s_mov_b64 s[16:17], s[84:85]
    s_mov_b64 s[20:21], s[60:61]
    s_mov_b64 s[24:25], s[98:99]
    s_mov_b64 s[28:29], s[86:87]
    s_mov_b64 s[32:33], s[88:89]
    s_mov_b64 s[36:37], s[92:93]
    s_mov_b64 s[40:41], s[64:65]
    s_mov_b64 s[44:45], s[90:91]
    s_mov_b64 s[48:49], s[94:95]
    s_mov_b64 s[52:53], s[96:97]
    s_cmp_ge_u32 s5, 4
    s_cbranch_scc1 F_hc
    s_cmp_eq_u32 s5, 0
    s_cbranch_scc0 F_tka
    s_mul_i32 s64, s2, 8192
    s_add_u32 s64, s64, 0
    v_min_u32 v2, 63, v0
    v_lshlrev_b32 v2, 7, v2
    buffer_load_dword v211, v2, s[16:19], s64 offen
    s_branch F_tkd
F_tka:
    s_cmp_eq_u32 s5, 1
    s_cbranch_scc0 F_tkb
    s_mul_i32 s64, s2, 2304
    s_add_u32 s64, s64, 0
    v_min_u32 v2, 17, v0
    v_lshlrev_b32 v2, 7, v2
    buffer_load_dword v211, v2, s[12:15], s64 offen
    s_mul_i32 s64, s2, 4096
    s_add_u32 s64, s64, 2097152
    v_min_u32 v2, 31, v0
    v_lshlrev_b32 v2, 7, v2
    buffer_load_dword v211, v2, s[16:19], s64 offen
    s_branch F_tkd
F_tkb:
    s_cmp_eq_u32 s5, 2
    s_cbranch_scc0 F_tkc
    s_lshl_b32 s64, s2, 14
    v_lshrrev_b32 v3, 3, v0
    v_and_b32 v2, 3, v0
    v_lshlrev_b32 v2, 7, v2
    v_lshl_add_u32 v2, v3, 11, v2
    buffer_load_dword v211, v2, s[8:11], s64 offen offset:0
    s_branch F_tkd
F_tkc:
    s_lshr_b32 s64, s2, 5
    s_lshl_b32 s64, s64, 13
    v_lshlrev_b32 v3, 7, v0
    buffer_load_dword v211, v3, s[20:23], s64 offen
    v_mov_b32 v4, -1
    v_mov_b32 v5, -1
    v_mov_b32 v6, -1
    v_mov_b32 v7, -1
    v_lshlrev_b32 v1, 4, v0
    s_lshl_b32 s64, s3, 4
    s_add_u32 s64, s64, s4
    s_lshl_b32 s65, s64, 10
    s_add_u32 s65, s65, 4456448
    buffer_store_dwordx4 v[4:7], v1, s[24:27], s65 offen sc1
    v_and_b32 v2, 16, v1
    s_lshl_b32 s65, s64, 5
    s_add_u32 s65, s65, 4718592
    buffer_store_dwordx4 v[4:7], v2, s[24:27], s65 offen sc1
    s_and_b32 s65, s2, 7
    s_lshl_b32 s65, s65, 5
    s_lshr_b32 s66, s2, 3
    s_add_u32 s65, s65, s66
    s_lshl_b32 s65, s65, 7
    s_add_u32 s65, s65, 4726784
    buffer_store_dwordx4 v[4:7], v2, s[24:27], s65 offen sc1
    s_lshl_b32 s65, s64, 7
    s_add_u32 s65, s65, 4759552
    buffer_store_dwordx4 v[4:7], v2, s[24:27], s65 offen sc1
    s_add_u32 s65, s65, 32768
    buffer_store_dwordx4 v[4:7], v2, s[24:27], s65 offen sc1
    s_add_u32 s65, s65, 32768
    buffer_store_dwordx4 v[4:7], v2, s[24:27], s65 offen sc1
    s_xor_b32 s65, s4, 0
    s_lshl_b32 s65, s65, 4
    s_add_u32 s65, s65, s3
    s_lshl_b32 s65, s65, 7
    s_add_u32 s65, s65, 4857856
    buffer_store_dwordx4 v[4:7], v2, s[24:27], s65 offen sc1
F_tkd:
    s_lshr_b32 s6, s5, 1
    s_and_b32 s7, s5, 1
    v_and_b32 v2, 15, v0
    v_lshrrev_b32 v3, 1, v2
    v_lshrrev_b32 v204, 4, v0
    v_xor_b32 v204, v204, v3
    v_lshlrev_b32 v204, 4, v204
    v_lshl_add_u32 v204, v2, 7, v204
    s_lshl_b32 s64, s6, 13
    v_add_u32 v204, s64, v204
    v_lshrrev_b32 v1, 2, v0
    v_and_b32 v2, 3, v0
    v_bfe_u32 v3, v1, 1, 2
    s_lshl_b32 s64, s7, 1
    v_xor_b32 v3, s64, v3
    v_lshlrev_b32 v3, 5, v3
    v_lshl_add_u32 v3, v1, 7, v3
    v_lshl_add_u32 v205, v2, 3, v3
    v_mul_u32_u24 v3, 224, v1
    v_lshl_add_u32 v3, v2, 3, v3
    s_mul_i32 s64, s7, 7168
    s_add_u32 s64, s64, 4096
    v_add_u32 v206, s64, v3
    s_mov_b32 s56, 49152
    s_mov_b32 s57, 0
    s_mov_b32 s63, 0
    s_lshr_b32 s72, s2, 3
    s_mul_i32 s72, s72, 1
    s_lshr_b32 s72, s72, 3
    s_add_u32 s72, s72, 1
    s_cmp_eq_u32 s5, 3
    s_cselect_b32 s72, s72, 16
    s_cselect_b32 s63, 0, 1
    s_mov_b32 s58, s72
    v_add_u32 v208, s56, v205
    v_add_u32 v210, s56, v206
    v_xor_b32 v209, 32, v208
    v_add_u32 v207, s57, v204
    v_mov_b32 v252, 0
    v_mov_b32 v253, 0
    v_mov_b32 v254, 0
    v_mov_b32 v255, 0
    v_mov_b32 v228, 0xc0135761
    v_mov_b32 v229, 0xc0135761
    v_mov_b32 v230, 0xbdd2d3e8
    v_mov_b32 v231, 0xbdd2d3e8
    v_mov_b32 v232, 0x3f800000
    v_mov_b32 v233, 0x3f800000
    s_mul_i32 s64, s7, 28672
    s_mul_i32 s65, s6, 14336
    s_add_u32 s64, s64, s65
    v_lshlrev_b32 v1, 4, v0
    v_add_u32 v234, s64, v1
    v_lshrrev_b32 v2, 3, v0
    v_and_b32 v223, 7, v0
    v_lshlrev_b32 v223, 4, v223
    v_lshl_add_u32 v223, v2, 10, v223
    v_lshrrev_b32 v4, 3, v0
    v_lshrrev_b32 v5, 2, v4
    v_xor_b32 v6, 0, v5
    v_lshlrev_b32 v6, 2, v6
    v_lshl_add_u32 v6, v5, 3, v6
    v_and_b32 v7, 3, v4
    v_add3_u32 v6, v6, v7, 0
    v_lshlrev_b32 v219, 12, v6
    v_lshrrev_b32 v6, 1, v4
    v_add_u32 v6, 0, v6
    v_and_b32 v7, 7, v0
    v_xor_b32 v6, v6, v7
    v_lshl_add_u32 v219, v6, 4, v219
    v_xor_b32 v6, 0, v5
    v_lshlrev_b32 v6, 2, v6
    v_lshl_add_u32 v6, v5, 3, v6
    v_and_b32 v7, 3, v4
    v_add3_u32 v6, v6, v7, 16
    v_lshlrev_b32 v220, 12, v6
    v_lshrrev_b32 v6, 1, v4
    v_add_u32 v6, 4, v6
    v_and_b32 v7, 7, v0
    v_xor_b32 v6, v6, v7
    v_lshl_add_u32 v220, v6, 4, v220
    v_xor_b32 v6, 1, v5
    v_lshlrev_b32 v6, 2, v6
    v_lshl_add_u32 v6, v5, 3, v6
    v_and_b32 v7, 3, v4
    v_add3_u32 v6, v6, v7, 0
    v_lshlrev_b32 v221, 12, v6
    v_lshrrev_b32 v6, 1, v4
    v_add_u32 v6, 0, v6
    v_and_b32 v7, 7, v0
    v_xor_b32 v6, v6, v7
    v_lshl_add_u32 v221, v6, 4, v221
    v_xor_b32 v6, 1, v5
    v_lshlrev_b32 v6, 2, v6
    v_lshl_add_u32 v6, v5, 3, v6
    v_and_b32 v7, 3, v4
    v_add3_u32 v6, v6, v7, 16
    v_lshlrev_b32 v222, 12, v6
    v_lshrrev_b32 v6, 1, v4
    v_add_u32 v6, 4, v6
    v_and_b32 v7, 7, v0
    v_xor_b32 v6, v6, v7
    v_lshl_add_u32 v222, v6, 4, v222
    v_lshrrev_b32 v2, 2, v0
    v_and_b32 v3, 3, v0
    v_lshlrev_b32 v2, 7, v2
    v_lshl_add_u32 v226, v3, 2, v2
    v_and_b32 v3, 15, v0
    v_cmp_eq_u32 vcc, 0, v3
    v_mov_b32 v2, 0x3f803f80
    v_mov_b32 v216, 0xdddd
    v_cndmask_b32 v212, 0, v2, vcc
    v_cndmask_b32 v213, 0, v2, vcc
    v_cmp_eq_u32 vcc, 4, v3
    v_add_u32 v218, 94208, v1
    v_bfe_u32 v5, v0, 2, 2
    v_and_b32 v4, 1, v5
    v_lshlrev_b32 v4, 2, v4
    v_lshl_add_u32 v4, v5, 3, v4
    v_and_b32 v5, 3, v0
    v_add_u32 v4, v4, v5
    v_cndmask_b32 v214, 0, v2, vcc
    v_cndmask_b32 v215, 0, v2, vcc
    v_bfe_u32 v2, v0, 4, 1
    v_lshlrev_b32 v3, 2, v2
    v_xor_b32 v3, v4, v3
    s_lshl_b32 s64, s3, 1
    s_add_u32 s64, s64, s6
    s_lshl_b32 s64, s64, 8
    s_add_u32 s64, s64, 4718592
    v_lshl_add_u32 v217, v3, 2, s64
    v_and_b32 v6, 15, v0
    v_lshlrev_b32 v6, 3, v6
    v_lshrrev_b32 v3, 5, v0
    v_lshl_add_u32 v6, v3, 10, v6
    v_mul_u32_u24 v2, 106496, v2
    s_lshl_b32 s64, s3, 1
    s_add_u32 s64, s64, s6
    s_mul_i32 s64, s64, 425984
    s_add_u32 s64, s64, 13631488
    v_add3_u32 v224, v6, v2, s64
    v_add_u32 v225, 212992, v224
    s_lshl_b32 s64, s4, 1
    s_add_u32 s64, s64, s7
    s_lshl_b32 s64, s64, 1
    s_mul_i32 s70, s64, 9363
    s_lshr_b32 s70, s70, 16
    s_mul_i32 s65, s70, 7
    s_sub_u32 s65, s64, s65
    s_cmp_ge_u32 s65, 3
    s_addc_u32 s65, s65, 0
    s_lshl_b32 s70, s70, 5
    s_add_u32 s70, s70, s65
    s_lshl_b32 s70, s70, 7
    s_add_u32 s64, s64, 1
    s_mul_i32 s71, s64, 9363
    s_lshr_b32 s71, s71, 16
    s_mul_i32 s65, s71, 7
    s_sub_u32 s65, s64, s65
    s_cmp_ge_u32 s65, 3
    s_addc_u32 s65, s65, 0
    s_lshl_b32 s71, s71, 5
    s_add_u32 s71, s71, s65
    s_lshl_b32 s71, s71, 7
    v_mfma_f32_32x32x16_bf16 v[4:19], v[252:255], v[252:255], 0
    v_mfma_f32_32x32x16_bf16 v[20:35], v[252:255], v[252:255], 0
    v_mfma_f32_32x32x16_bf16 v[36:51], v[252:255], v[252:255], 0
    v_mfma_f32_32x32x16_bf16 v[52:67], v[252:255], v[252:255], 0
    v_mfma_f32_32x32x16_bf16 v[68:83], v[252:255], v[252:255], 0
    v_mfma_f32_32x32x16_bf16 v[84:99], v[252:255], v[252:255], 0
    v_mfma_f32_32x32x16_bf16 v[100:115], v[252:255], v[252:255], 0
    v_mfma_f32_32x32x16_bf16 v[116:131], v[252:255], v[252:255], 0
    v_mfma_f32_32x32x16_bf16 v[132:147], v[252:255], v[252:255], 0
    v_mfma_f32_32x32x16_bf16 v[236:251], v[252:255], v[252:255], 0
    s_barrier
    ds_read_b128 v[148:151], v207 offset:0
    ds_read_b64_tr_b16 v[180:181], v208 offset:0
    ds_read_b64_tr_b16 v[182:183], v208 offset:2048
    ds_read_b128 v[152:155], v207 offset:2048
    ds_read_b128 v[156:159], v207 offset:4096
    ds_read_b128 v[160:163], v207 offset:6144
    ds_read_b64_tr_b16 v[184:185], v209 offset:0
    ds_read_b64_tr_b16 v[186:187], v209 offset:2048
    ds_read_b64_tr_b16 v[188:189], v210 offset:0
    ds_read_b64_tr_b16 v[190:191], v210 offset:3584
    s_waitcnt lgkmcnt(4)
    .p2align 6
F_c1:
    v_mfma_f32_16x16x32_bf16 v[4:7], v[180:183], v[148:151], v[4:7]
    ds_read_b64_tr_b16 v[192:193], v210 offset:32
    v_mfma_f32_16x16x32_bf16 v[8:11], v[180:183], v[152:155], v[8:11]
    ds_read_b64_tr_b16 v[194:195], v210 offset:3616
    v_mfma_f32_16x16x32_bf16 v[12:15], v[180:183], v[156:159], v[12:15]
    ds_read_b64_tr_b16 v[196:197], v210 offset:64
    v_mfma_f32_16x16x32_bf16 v[16:19], v[180:183], v[160:163], v[16:19]
    s_waitcnt lgkmcnt(5)
    v_mfma_f32_16x16x32_bf16 v[32:35], v[184:187], v[160:163], v[32:35]
    ds_read_b64_tr_b16 v[198:199], v210 offset:3648
    v_mfma_f32_16x16x32_bf16 v[28:31], v[184:187], v[156:159], v[28:31]
    ds_read_b64_tr_b16 v[200:201], v210 offset:96
    v_mfma_f32_16x16x32_bf16 v[24:27], v[184:187], v[152:155], v[24:27]
    ds_read_b64_tr_b16 v[202:203], v210 offset:3680
    v_mfma_f32_16x16x32_bf16 v[20:23], v[184:187], v[148:151], v[20:23]
    s_waitcnt lgkmcnt(6)
    v_mfma_f32_16x16x32_bf16 v[36:39], v[188:191], v[148:151], v[36:39]
    ds_read_b64_tr_b16 v[180:181], v210 offset:128
    v_mfma_f32_16x16x32_bf16 v[40:43], v[188:191], v[152:155], v[40:43]
    ds_read_b64_tr_b16 v[182:183], v210 offset:3712
    v_mfma_f32_16x16x32_bf16 v[44:47], v[188:191], v[156:159], v[44:47]
    s_add_u32 s56, s56, 19456
    s_cmp_eq_u32 s56, 146432
    v_mfma_f32_16x16x32_bf16 v[48:51], v[188:191], v[160:163], v[48:51]
    s_waitcnt lgkmcnt(6)
    v_mfma_f32_16x16x32_bf16 v[64:67], v[192:195], v[160:163], v[64:67]
    ds_read_b64_tr_b16 v[184:185], v210 offset:160
    v_mfma_f32_16x16x32_bf16 v[60:63], v[192:195], v[156:159], v[60:63]
    ds_read_b64_tr_b16 v[186:187], v210 offset:3744
    v_mfma_f32_16x16x32_bf16 v[56:59], v[192:195], v[152:155], v[56:59]
    s_cselect_b32 s56, 49152, s56
    v_mfma_f32_16x16x32_bf16 v[52:55], v[192:195], v[148:151], v[52:55]
    s_waitcnt lgkmcnt(6)
    v_mfma_f32_16x16x32_bf16 v[68:71], v[196:199], v[148:151], v[68:71]
    ds_read_b64_tr_b16 v[188:189], v210 offset:192
    v_mfma_f32_16x16x32_bf16 v[72:75], v[196:199], v[152:155], v[72:75]
    ds_read_b64_tr_b16 v[190:191], v210 offset:3776
    v_mfma_f32_16x16x32_bf16 v[76:79], v[196:199], v[156:159], v[76:79]
    v_mfma_f32_16x16x32_bf16 v[80:83], v[196:199], v[160:163], v[80:83]
    s_waitcnt lgkmcnt(6)
    v_mfma_f32_16x16x32_bf16 v[96:99], v[200:203], v[160:163], v[96:99]
    v_add_u32 v208, s56, v205
    v_add_u32 v210, s56, v206
    v_mfma_f32_16x16x32_bf16 v[92:95], v[200:203], v[156:159], v[92:95]
    v_xor_b32 v209, 32, v208
    v_xor_b32 v207, 64, v207
    v_mfma_f32_16x16x32_bf16 v[88:91], v[200:203], v[152:155], v[88:91]
    s_waitcnt lgkmcnt(0)
    v_mfma_f32_16x16x32_bf16 v[84:87], v[200:203], v[148:151], v[84:87]
    s_barrier
    v_mfma_f32_16x16x32_bf16 v[100:103], v[180:183], v[148:151], v[100:103]
    ds_read_b128 v[164:167], v207 offset:0
    v_mfma_f32_16x16x32_bf16 v[104:107], v[180:183], v[152:155], v[104:107]
    ds_read_b64_tr_b16 v[192:193], v208 offset:0
    v_mfma_f32_16x16x32_bf16 v[108:111], v[180:183], v[156:159], v[108:111]
    ds_read_b64_tr_b16 v[194:195], v208 offset:2048
    v_mfma_f32_16x16x32_bf16 v[112:115], v[180:183], v[160:163], v[112:115]
    ds_read_b128 v[168:171], v207 offset:2048
    v_mfma_f32_16x16x32_bf16 v[128:131], v[184:187], v[160:163], v[128:131]
    ds_read_b128 v[172:175], v207 offset:4096
    v_mfma_f32_16x16x32_bf16 v[124:127], v[184:187], v[156:159], v[124:127]
    ds_read_b128 v[176:179], v207 offset:6144
    v_mfma_f32_16x16x32_bf16 v[120:123], v[184:187], v[152:155], v[120:123]
    ds_read_b64_tr_b16 v[196:197], v209 offset:0
    v_mfma_f32_16x16x32_bf16 v[116:119], v[184:187], v[148:151], v[116:119]
    ds_read_b64_tr_b16 v[198:199], v209 offset:2048
    v_mfma_f32_16x16x32_bf16 v[132:135], v[188:191], v[148:151], v[132:135]
    ds_read_b64_tr_b16 v[200:201], v210 offset:0
    v_mfma_f32_16x16x32_bf16 v[136:139], v[188:191], v[152:155], v[136:139]
    ds_read_b64_tr_b16 v[202:203], v210 offset:3584
    v_mfma_f32_16x16x32_bf16 v[140:143], v[188:191], v[156:159], v[140:143]
    v_mfma_f32_16x16x32_bf16 v[144:147], v[188:191], v[160:163], v[144:147]
    s_waitcnt lgkmcnt(4)
    v_mfma_f32_16x16x32_bf16 v[4:7], v[192:195], v[164:167], v[4:7]
    ds_read_b64_tr_b16 v[180:181], v210 offset:32
    v_mfma_f32_16x16x32_bf16 v[8:11], v[192:195], v[168:171], v[8:11]
    ds_read_b64_tr_b16 v[182:183], v210 offset:3616
    v_mfma_f32_16x16x32_bf16 v[12:15], v[192:195], v[172:175], v[12:15]
    ds_read_b64_tr_b16 v[184:185], v210 offset:64
    v_mfma_f32_16x16x32_bf16 v[16:19], v[192:195], v[176:179], v[16:19]
    s_waitcnt lgkmcnt(5)
    v_mfma_f32_16x16x32_bf16 v[32:35], v[196:199], v[176:179], v[32:35]
    ds_read_b64_tr_b16 v[186:187], v210 offset:3648
    v_mfma_f32_16x16x32_bf16 v[28:31], v[196:199], v[172:175], v[28:31]
    ds_read_b64_tr_b16 v[188:189], v210 offset:96
    v_mfma_f32_16x16x32_bf16 v[24:27], v[196:199], v[168:171], v[24:27]
    ds_read_b64_tr_b16 v[190:191], v210 offset:3680
    v_mfma_f32_16x16x32_bf16 v[20:23], v[196:199], v[164:167], v[20:23]
    s_waitcnt lgkmcnt(6)
    v_mfma_f32_16x16x32_bf16 v[36:39], v[200:203], v[164:167], v[36:39]
    ds_read_b64_tr_b16 v[192:193], v210 offset:128
    v_mfma_f32_16x16x32_bf16 v[40:43], v[200:203], v[168:171], v[40:43]
    ds_read_b64_tr_b16 v[194:195], v210 offset:3712
    v_mfma_f32_16x16x32_bf16 v[44:47], v[200:203], v[172:175], v[44:47]
    s_add_u32 s56, s56, 19456
    s_cmp_eq_u32 s56, 146432
    v_mfma_f32_16x16x32_bf16 v[48:51], v[200:203], v[176:179], v[48:51]
    s_waitcnt lgkmcnt(6)
    v_mfma_f32_16x16x32_bf16 v[64:67], v[180:183], v[176:179], v[64:67]
    ds_read_b64_tr_b16 v[196:197], v210 offset:160
    v_mfma_f32_16x16x32_bf16 v[60:63], v[180:183], v[172:175], v[60:63]
    ds_read_b64_tr_b16 v[198:199], v210 offset:3744
    v_mfma_f32_16x16x32_bf16 v[56:59], v[180:183], v[168:171], v[56:59]
    s_cselect_b32 s56, 49152, s56
    s_add_u32 s57, s57, 16384
    v_mfma_f32_16x16x32_bf16 v[52:55], v[180:183], v[164:167], v[52:55]
    s_waitcnt lgkmcnt(6)
    v_mfma_f32_16x16x32_bf16 v[68:71], v[184:187], v[164:167], v[68:71]
    ds_read_b64_tr_b16 v[200:201], v210 offset:192
    v_mfma_f32_16x16x32_bf16 v[72:75], v[184:187], v[168:171], v[72:75]
    ds_read_b64_tr_b16 v[202:203], v210 offset:3776
    v_mfma_f32_16x16x32_bf16 v[76:79], v[184:187], v[172:175], v[76:79]
    s_cmp_eq_u32 s57, 49152
    s_cselect_b32 s57, 0, s57
    v_mfma_f32_16x16x32_bf16 v[80:83], v[184:187], v[176:179], v[80:83]
    s_waitcnt lgkmcnt(6)
    v_mfma_f32_16x16x32_bf16 v[96:99], v[188:191], v[176:179], v[96:99]
    v_add_u32 v208, s56, v205
    v_add_u32 v210, s56, v206
    v_mfma_f32_16x16x32_bf16 v[92:95], v[188:191], v[172:175], v[92:95]
    v_xor_b32 v209, 32, v208
    v_add_u32 v207, s57, v204
    v_mfma_f32_16x16x32_bf16 v[88:91], v[188:191], v[168:171], v[88:91]
    s_waitcnt lgkmcnt(0)
    v_mfma_f32_16x16x32_bf16 v[84:87], v[188:191], v[164:167], v[84:87]
    s_barrier
    v_mfma_f32_16x16x32_bf16 v[100:103], v[192:195], v[164:167], v[100:103]
    ds_read_b128 v[148:151], v207 offset:0
    v_mfma_f32_16x16x32_bf16 v[104:107], v[192:195], v[168:171], v[104:107]
    ds_read_b64_tr_b16 v[180:181], v208 offset:0
    v_mfma_f32_16x16x32_bf16 v[108:111], v[192:195], v[172:175], v[108:111]
    ds_read_b64_tr_b16 v[182:183], v208 offset:2048
    v_mfma_f32_16x16x32_bf16 v[112:115], v[192:195], v[176:179], v[112:115]
    ds_read_b128 v[152:155], v207 offset:2048
    v_mfma_f32_16x16x32_bf16 v[128:131], v[196:199], v[176:179], v[128:131]
    ds_read_b128 v[156:159], v207 offset:4096
    v_mfma_f32_16x16x32_bf16 v[124:127], v[196:199], v[172:175], v[124:127]
    ds_read_b128 v[160:163], v207 offset:6144
    v_mfma_f32_16x16x32_bf16 v[120:123], v[196:199], v[168:171], v[120:123]
    ds_read_b64_tr_b16 v[184:185], v209 offset:0
    v_mfma_f32_16x16x32_bf16 v[116:119], v[196:199], v[164:167], v[116:119]
    ds_read_b64_tr_b16 v[186:187], v209 offset:2048
    v_mfma_f32_16x16x32_bf16 v[132:135], v[200:203], v[164:167], v[132:135]
    ds_read_b64_tr_b16 v[188:189], v210 offset:0
    v_mfma_f32_16x16x32_bf16 v[136:139], v[200:203], v[168:171], v[136:139]
    ds_read_b64_tr_b16 v[190:191], v210 offset:3584
    v_mfma_f32_16x16x32_bf16 v[140:143], v[200:203], v[172:175], v[140:143]
    s_sub_u32 s58, s58, 1
    s_cmp_lg_u32 s58, 0
    v_mfma_f32_16x16x32_bf16 v[144:147], v[200:203], v[176:179], v[144:147]
    s_waitcnt lgkmcnt(4)
    s_cbranch_scc1 F_c1
    s_cmp_lg_u32 s63, 0
    s_cbranch_scc1 F_e1
    s_mov_b32 s63, 1
    s_sub_u32 s58, 16, s72
    s_lshl_b32 s65, s3, 4
    v_mov_b32 v2, 1
    v_lshlrev_b32 v3, 8, v0
    s_waitcnt vmcnt(0)
    buffer_atomic_add v2, v3, s[52:55], s65 offen sc1
    s_branch F_c1
F_e1:
    v_cvt_pk_bf16_f32 v4, v4, v5
    v_cvt_pk_bf16_f32 v5, v6, v7
    v_cvt_pk_bf16_f32 v6, v20, v21
    v_cvt_pk_bf16_f32 v7, v22, v23
    v_cvt_pk_bf16_f32 v8, v8, v9
    v_cvt_pk_bf16_f32 v9, v10, v11
    v_cvt_pk_bf16_f32 v10, v24, v25
    v_cvt_pk_bf16_f32 v11, v26, v27
    v_cvt_pk_bf16_f32 v12, v12, v13
    v_cvt_pk_bf16_f32 v13, v14, v15
    v_cvt_pk_bf16_f32 v14, v28, v29
    v_cvt_pk_bf16_f32 v15, v30, v31
    v_cvt_pk_bf16_f32 v16, v16, v17
    v_cvt_pk_bf16_f32 v17, v18, v19
    v_cvt_pk_bf16_f32 v18, v32, v33
    v_cvt_pk_bf16_f32 v19, v34, v35
    v_permlane16_swap_b32 v4, v8
    v_permlane16_swap_b32 v5, v9
    v_permlane16_swap_b32 v6, v10
    v_permlane16_swap_b32 v7, v11
    v_permlane16_swap_b32 v12, v16
    v_permlane16_swap_b32 v13, v17
    v_permlane16_swap_b32 v14, v18
    v_permlane16_swap_b32 v15, v19
    v_pk_mul_f32 v[28:29], v[36:37], v[36:37]
    v_pk_mul_f32 v[30:31], v[38:39], v[38:39]
    v_pk_mul_f32 v[32:33], v[40:41], v[40:41]
    v_pk_mul_f32 v[34:35], v[42:43], v[42:43]
    v_pk_fma_f32 v[28:29], v[28:29], v[230:231], v[228:229]
    v_pk_fma_f32 v[30:31], v[30:31], v[230:231], v[228:229]
    v_pk_fma_f32 v[32:33], v[32:33], v[230:231], v[228:229]
    v_pk_fma_f32 v[34:35], v[34:35], v[230:231], v[228:229]
    v_pk_mul_f32 v[28:29], v[28:29], v[36:37]
    v_pk_mul_f32 v[30:31], v[30:31], v[38:39]
    v_pk_mul_f32 v[32:33], v[32:33], v[40:41]
    v_pk_mul_f32 v[34:35], v[34:35], v[42:43]
    v_exp_f32 v28, v28
    v_exp_f32 v29, v29
    v_exp_f32 v30, v30
    v_exp_f32 v31, v31
    v_exp_f32 v32, v32
    v_exp_f32 v33, v33
    v_exp_f32 v34, v34
    v_exp_f32 v35, v35
    v_pk_add_f32 v[28:29], v[28:29], v[232:233]
    v_pk_add_f32 v[30:31], v[30:31], v[232:233]
    v_pk_add_f32 v[32:33], v[32:33], v[232:233]
    v_pk_add_f32 v[34:35], v[34:35], v[232:233]
    v_rcp_f32 v28, v28
    v_rcp_f32 v29, v29
    v_rcp_f32 v30, v30
    v_rcp_f32 v31, v31
    v_rcp_f32 v32, v32
    v_rcp_f32 v33, v33
    v_rcp_f32 v34, v34
    v_rcp_f32 v35, v35
    v_pk_mul_f32 v[36:37], v[36:37], v[28:29]
    v_pk_mul_f32 v[38:39], v[38:39], v[30:31]
    v_pk_mul_f32 v[40:41], v[40:41], v[32:33]
    v_pk_mul_f32 v[42:43], v[42:43], v[34:35]
    v_cvt_pk_bf16_f32 v20, v36, v37
    v_cvt_pk_bf16_f32 v21, v38, v39
    v_cvt_pk_bf16_f32 v22, v40, v41
    v_cvt_pk_bf16_f32 v23, v42, v43
    ds_write_b128 v234, v[20:23] offset:0
    v_pk_add_f32 v[236:237], v[236:237], v[36:37]
    v_pk_fma_f32 v[244:245], v[36:37], v[36:37], v[244:245]
    v_pk_add_f32 v[238:239], v[238:239], v[40:41]
    v_pk_fma_f32 v[246:247], v[40:41], v[40:41], v[246:247]
    v_pk_add_f32 v[236:237], v[236:237], v[38:39]
    v_pk_fma_f32 v[244:245], v[38:39], v[38:39], v[244:245]
    v_pk_add_f32 v[238:239], v[238:239], v[42:43]
    v_pk_fma_f32 v[246:247], v[42:43], v[42:43], v[246:247]
    v_pk_mul_f32 v[28:29], v[44:45], v[44:45]
    v_pk_mul_f32 v[30:31], v[46:47], v[46:47]
    v_pk_mul_f32 v[32:33], v[48:49], v[48:49]
    v_pk_mul_f32 v[34:35], v[50:51], v[50:51]
    v_pk_fma_f32 v[28:29], v[28:29], v[230:231], v[228:229]
    v_pk_fma_f32 v[30:31], v[30:31], v[230:231], v[228:229]
    v_pk_fma_f32 v[32:33], v[32:33], v[230:231], v[228:229]
    v_pk_fma_f32 v[34:35], v[34:35], v[230:231], v[228:229]
    v_pk_mul_f32 v[28:29], v[28:29], v[44:45]
    v_pk_mul_f32 v[30:31], v[30:31], v[46:47]
    v_pk_mul_f32 v[32:33], v[32:33], v[48:49]
    v_pk_mul_f32 v[34:35], v[34:35], v[50:51]
    v_exp_f32 v28, v28
    v_exp_f32 v29, v29
    v_exp_f32 v30, v30
    v_exp_f32 v31, v31
    v_exp_f32 v32, v32
    v_exp_f32 v33, v33
    v_exp_f32 v34, v34
    v_exp_f32 v35, v35
    v_pk_add_f32 v[28:29], v[28:29], v[232:233]
    v_pk_add_f32 v[30:31], v[30:31], v[232:233]
    v_pk_add_f32 v[32:33], v[32:33], v[232:233]
    v_pk_add_f32 v[34:35], v[34:35], v[232:233]
    v_rcp_f32 v28, v28
    v_rcp_f32 v29, v29
    v_rcp_f32 v30, v30
    v_rcp_f32 v31, v31
    v_rcp_f32 v32, v32
    v_rcp_f32 v33, v33
    v_rcp_f32 v34, v34
    v_rcp_f32 v35, v35
    v_pk_mul_f32 v[44:45], v[44:45], v[28:29]
    v_pk_mul_f32 v[46:47], v[46:47], v[30:31]
    v_pk_mul_f32 v[48:49], v[48:49], v[32:33]
    v_pk_mul_f32 v[50:51], v[50:51], v[34:35]
    v_cvt_pk_bf16_f32 v24, v44, v45
    v_cvt_pk_bf16_f32 v25, v46, v47
    v_cvt_pk_bf16_f32 v26, v48, v49
    v_cvt_pk_bf16_f32 v27, v50, v51
    ds_write_b128 v234, v[24:27] offset:7168
    v_pk_add_f32 v[240:241], v[240:241], v[44:45]
    v_pk_fma_f32 v[248:249], v[44:45], v[44:45], v[248:249]
    v_pk_add_f32 v[242:243], v[242:243], v[48:49]
    v_pk_fma_f32 v[250:251], v[48:49], v[48:49], v[250:251]
    v_pk_add_f32 v[240:241], v[240:241], v[46:47]
    v_pk_fma_f32 v[248:249], v[46:47], v[46:47], v[248:249]
    v_pk_add_f32 v[242:243], v[242:243], v[50:51]
    v_pk_fma_f32 v[250:251], v[50:51], v[50:51], v[250:251]
    v_pk_mul_f32 v[28:29], v[52:53], v[52:53]
    v_pk_mul_f32 v[30:31], v[54:55], v[54:55]
    v_pk_mul_f32 v[32:33], v[56:57], v[56:57]
    v_pk_mul_f32 v[34:35], v[58:59], v[58:59]
    v_pk_fma_f32 v[28:29], v[28:29], v[230:231], v[228:229]
    v_pk_fma_f32 v[30:31], v[30:31], v[230:231], v[228:229]
    v_pk_fma_f32 v[32:33], v[32:33], v[230:231], v[228:229]
    v_pk_fma_f32 v[34:35], v[34:35], v[230:231], v[228:229]
    v_pk_mul_f32 v[28:29], v[28:29], v[52:53]
    v_pk_mul_f32 v[30:31], v[30:31], v[54:55]
    v_pk_mul_f32 v[32:33], v[32:33], v[56:57]
    v_pk_mul_f32 v[34:35], v[34:35], v[58:59]
    v_exp_f32 v28, v28
    v_exp_f32 v29, v29
    v_exp_f32 v30, v30
    v_exp_f32 v31, v31
    v_exp_f32 v32, v32
    v_exp_f32 v33, v33
    v_exp_f32 v34, v34
    v_exp_f32 v35, v35
    v_pk_add_f32 v[28:29], v[28:29], v[232:233]
    v_pk_add_f32 v[30:31], v[30:31], v[232:233]
    v_pk_add_f32 v[32:33], v[32:33], v[232:233]
    v_pk_add_f32 v[34:35], v[34:35], v[232:233]
    v_rcp_f32 v28, v28
    v_rcp_f32 v29, v29
    v_rcp_f32 v30, v30
    v_rcp_f32 v31, v31
    v_rcp_f32 v32, v32
    v_rcp_f32 v33, v33
    v_rcp_f32 v34, v34
    v_rcp_f32 v35, v35
    v_pk_mul_f32 v[52:53], v[52:53], v[28:29]
    v_pk_mul_f32 v[54:55], v[54:55], v[30:31]
    v_pk_mul_f32 v[56:57], v[56:57], v[32:33]
    v_pk_mul_f32 v[58:59], v[58:59], v[34:35]
    v_cvt_pk_bf16_f32 v20, v52, v53
    v_cvt_pk_bf16_f32 v21, v54, v55
    v_cvt_pk_bf16_f32 v22, v56, v57
    v_cvt_pk_bf16_f32 v23, v58, v59
    ds_write_b128 v234, v[20:23] offset:1024
    v_pk_add_f32 v[236:237], v[236:237], v[52:53]
    v_pk_fma_f32 v[244:245], v[52:53], v[52:53], v[244:245]
    v_pk_add_f32 v[238:239], v[238:239], v[56:57]
    v_pk_fma_f32 v[246:247], v[56:57], v[56:57], v[246:247]
    v_pk_add_f32 v[236:237], v[236:237], v[54:55]
    v_pk_fma_f32 v[244:245], v[54:55], v[54:55], v[244:245]
    v_pk_add_f32 v[238:239], v[238:239], v[58:59]
    v_pk_fma_f32 v[246:247], v[58:59], v[58:59], v[246:247]
    v_pk_mul_f32 v[28:29], v[60:61], v[60:61]
    v_pk_mul_f32 v[30:31], v[62:63], v[62:63]
    v_pk_mul_f32 v[32:33], v[64:65], v[64:65]
    v_pk_mul_f32 v[34:35], v[66:67], v[66:67]
    v_pk_fma_f32 v[28:29], v[28:29], v[230:231], v[228:229]
    v_pk_fma_f32 v[30:31], v[30:31], v[230:231], v[228:229]
    v_pk_fma_f32 v[32:33], v[32:33], v[230:231], v[228:229]
    v_pk_fma_f32 v[34:35], v[34:35], v[230:231], v[228:229]
    v_pk_mul_f32 v[28:29], v[28:29], v[60:61]
    v_pk_mul_f32 v[30:31], v[30:31], v[62:63]
    v_pk_mul_f32 v[32:33], v[32:33], v[64:65]
    v_pk_mul_f32 v[34:35], v[34:35], v[66:67]
    v_exp_f32 v28, v28
    v_exp_f32 v29, v29
    v_exp_f32 v30, v30
    v_exp_f32 v31, v31
    v_exp_f32 v32, v32
    v_exp_f32 v33, v33
    v_exp_f32 v34, v34
    v_exp_f32 v35, v35
    v_pk_add_f32 v[28:29], v[28:29], v[232:233]
    v_pk_add_f32 v[30:31], v[30:31], v[232:233]
    v_pk_add_f32 v[32:33], v[32:33], v[232:233]
    v_pk_add_f32 v[34:35], v[34:35], v[232:233]
    v_rcp_f32 v28, v28
    v_rcp_f32 v29, v29
    v_rcp_f32 v30, v30
    v_rcp_f32 v31, v31
    v_rcp_f32 v32, v32
    v_rcp_f32 v33, v33
    v_rcp_f32 v34, v34
    v_rcp_f32 v35, v35
    v_pk_mul_f32 v[60:61], v[60:61], v[28:29]
    v_pk_mul_f32 v[62:63], v[62:63], v[30:31]
    v_pk_mul_f32 v[64:65], v[64:65], v[32:33]
    v_pk_mul_f32 v[66:67], v[66:67], v[34:35]
    v_cvt_pk_bf16_f32 v24, v60, v61
    v_cvt_pk_bf16_f32 v25, v62, v63
    v_cvt_pk_bf16_f32 v26, v64, v65
    v_cvt_pk_bf16_f32 v27, v66, v67
    ds_write_b128 v234, v[24:27] offset:8192
    v_pk_add_f32 v[240:241], v[240:241], v[60:61]
    v_pk_fma_f32 v[248:249], v[60:61], v[60:61], v[248:249]
    v_pk_add_f32 v[242:243], v[242:243], v[64:65]
    v_pk_fma_f32 v[250:251], v[64:65], v[64:65], v[250:251]
    v_pk_add_f32 v[240:241], v[240:241], v[62:63]
    v_pk_fma_f32 v[248:249], v[62:63], v[62:63], v[248:249]
    v_pk_add_f32 v[242:243], v[242:243], v[66:67]
    v_pk_fma_f32 v[250:251], v[66:67], v[66:67], v[250:251]
    v_pk_mul_f32 v[28:29], v[68:69], v[68:69]
    v_pk_mul_f32 v[30:31], v[70:71], v[70:71]
    v_pk_mul_f32 v[32:33], v[72:73], v[72:73]
    v_pk_mul_f32 v[34:35], v[74:75], v[74:75]
    v_pk_fma_f32 v[28:29], v[28:29], v[230:231], v[228:229]
    v_pk_fma_f32 v[30:31], v[30:31], v[230:231], v[228:229]
    v_pk_fma_f32 v[32:33], v[32:33], v[230:231], v[228:229]
    v_pk_fma_f32 v[34:35], v[34:35], v[230:231], v[228:229]
    v_pk_mul_f32 v[28:29], v[28:29], v[68:69]
    v_pk_mul_f32 v[30:31], v[30:31], v[70:71]
    v_pk_mul_f32 v[32:33], v[32:33], v[72:73]
    v_pk_mul_f32 v[34:35], v[34:35], v[74:75]
    v_exp_f32 v28, v28
    v_exp_f32 v29, v29
    v_mfma_f32_32x32x16_bf16 v[36:51], v[252:255], v[252:255], 0
    v_exp_f32 v30, v30
    v_exp_f32 v31, v31
    v_exp_f32 v32, v32
    v_exp_f32 v33, v33
    v_exp_f32 v34, v34
    v_exp_f32 v35, v35
    v_pk_add_f32 v[28:29], v[28:29], v[232:233]
    v_pk_add_f32 v[30:31], v[30:31], v[232:233]
    v_pk_add_f32 v[32:33], v[32:33], v[232:233]
    v_pk_add_f32 v[34:35], v[34:35], v[232:233]
    v_rcp_f32 v28, v28
    v_rcp_f32 v29, v29
    v_rcp_f32 v30, v30
    v_rcp_f32 v31, v31
    v_rcp_f32 v32, v32
    v_rcp_f32 v33, v33
    v_rcp_f32 v34, v34
    v_rcp_f32 v35, v35
    v_pk_mul_f32 v[68:69], v[68:69], v[28:29]
    v_pk_mul_f32 v[70:71], v[70:71], v[30:31]
    v_pk_mul_f32 v[72:73], v[72:73], v[32:33]
    v_pk_mul_f32 v[74:75], v[74:75], v[34:35]
    v_cvt_pk_bf16_f32 v20, v68, v69
    v_cvt_pk_bf16_f32 v21, v70, v71
    v_cvt_pk_bf16_f32 v22, v72, v73
    v_cvt_pk_bf16_f32 v23, v74, v75
    ds_write_b128 v234, v[20:23] offset:2048
    v_pk_add_f32 v[236:237], v[236:237], v[68:69]
    v_pk_fma_f32 v[244:245], v[68:69], v[68:69], v[244:245]
    v_pk_add_f32 v[238:239], v[238:239], v[72:73]
    v_pk_fma_f32 v[246:247], v[72:73], v[72:73], v[246:247]
    v_pk_add_f32 v[236:237], v[236:237], v[70:71]
    v_pk_fma_f32 v[244:245], v[70:71], v[70:71], v[244:245]
    v_pk_add_f32 v[238:239], v[238:239], v[74:75]
    v_pk_fma_f32 v[246:247], v[74:75], v[74:75], v[246:247]
    v_pk_mul_f32 v[28:29], v[76:77], v[76:77]
    v_pk_mul_f32 v[30:31], v[78:79], v[78:79]
    v_pk_mul_f32 v[32:33], v[80:81], v[80:81]
    v_pk_mul_f32 v[34:35], v[82:83], v[82:83]
    v_pk_fma_f32 v[28:29], v[28:29], v[230:231], v[228:229]
    v_pk_fma_f32 v[30:31], v[30:31], v[230:231], v[228:229]
    v_pk_fma_f32 v[32:33], v[32:33], v[230:231], v[228:229]
    v_pk_fma_f32 v[34:35], v[34:35], v[230:231], v[228:229]
    v_pk_mul_f32 v[28:29], v[28:29], v[76:77]
    v_pk_mul_f32 v[30:31], v[30:31], v[78:79]
    v_pk_mul_f32 v[32:33], v[32:33], v[80:81]
    v_pk_mul_f32 v[34:35], v[34:35], v[82:83]
    v_exp_f32 v28, v28
    v_exp_f32 v29, v29
    v_mfma_f32_32x32x16_bf16 v[52:67], v[252:255], v[252:255], 0
    v_exp_f32 v30, v30
    v_exp_f32 v31, v31
    v_exp_f32 v32, v32
    v_exp_f32 v33, v33
    v_exp_f32 v34, v34
    v_exp_f32 v35, v35
    v_pk_add_f32 v[28:29], v[28:29], v[232:233]
    v_pk_add_f32 v[30:31], v[30:31], v[232:233]
    v_pk_add_f32 v[32:33], v[32:33], v[232:233]
    v_pk_add_f32 v[34:35], v[34:35], v[232:233]
    v_rcp_f32 v28, v28
    v_rcp_f32 v29, v29
    v_rcp_f32 v30, v30
    v_rcp_f32 v31, v31
    v_rcp_f32 v32, v32
    v_rcp_f32 v33, v33
    v_rcp_f32 v34, v34
    v_rcp_f32 v35, v35
    v_pk_mul_f32 v[76:77], v[76:77], v[28:29]
    v_pk_mul_f32 v[78:79], v[78:79], v[30:31]
    v_pk_mul_f32 v[80:81], v[80:81], v[32:33]
    v_pk_mul_f32 v[82:83], v[82:83], v[34:35]
    v_cvt_pk_bf16_f32 v24, v76, v77
    v_cvt_pk_bf16_f32 v25, v78, v79
    v_cvt_pk_bf16_f32 v26, v80, v81
    v_cvt_pk_bf16_f32 v27, v82, v83
    ds_write_b128 v234, v[24:27] offset:9216
    v_pk_add_f32 v[240:241], v[240:241], v[76:77]
    v_pk_fma_f32 v[248:249], v[76:77], v[76:77], v[248:249]
    v_pk_add_f32 v[242:243], v[242:243], v[80:81]
    v_pk_fma_f32 v[250:251], v[80:81], v[80:81], v[250:251]
    v_pk_add_f32 v[240:241], v[240:241], v[78:79]
    v_pk_fma_f32 v[248:249], v[78:79], v[78:79], v[248:249]
    v_pk_add_f32 v[242:243], v[242:243], v[82:83]
    v_pk_fma_f32 v[250:251], v[82:83], v[82:83], v[250:251]
    v_pk_mul_f32 v[28:29], v[84:85], v[84:85]
    v_pk_mul_f32 v[30:31], v[86:87], v[86:87]
    v_pk_mul_f32 v[32:33], v[88:89], v[88:89]
    v_pk_mul_f32 v[34:35], v[90:91], v[90:91]
    v_pk_fma_f32 v[28:29], v[28:29], v[230:231], v[228:229]
    v_pk_fma_f32 v[30:31], v[30:31], v[230:231], v[228:229]
    v_pk_fma_f32 v[32:33], v[32:33], v[230:231], v[228:229]
    v_pk_fma_f32 v[34:35], v[34:35], v[230:231], v[228:229]
    v_pk_mul_f32 v[28:29], v[28:29], v[84:85]
    v_pk_mul_f32 v[30:31], v[30:31], v[86:87]
    v_pk_mul_f32 v[32:33], v[32:33], v[88:89]
    v_pk_mul_f32 v[34:35], v[34:35], v[90:91]
    v_exp_f32 v28, v28
    v_exp_f32 v29, v29
    v_mfma_f32_32x32x16_bf16 v[68:83], v[252:255], v[252:255], 0
    v_exp_f32 v30, v30
    v_exp_f32 v31, v31
    v_exp_f32 v32, v32
    v_exp_f32 v33, v33
    v_exp_f32 v34, v34
    v_exp_f32 v35, v35
    v_pk_add_f32 v[28:29], v[28:29], v[232:233]
    v_pk_add_f32 v[30:31], v[30:31], v[232:233]
    v_pk_add_f32 v[32:33], v[32:33], v[232:233]
    v_pk_add_f32 v[34:35], v[34:35], v[232:233]
    v_rcp_f32 v28, v28
    v_rcp_f32 v29, v29
    v_rcp_f32 v30, v30
    v_rcp_f32 v31, v31
    v_rcp_f32 v32, v32
    v_rcp_f32 v33, v33
    v_rcp_f32 v34, v34
    v_rcp_f32 v35, v35
    v_pk_mul_f32 v[84:85], v[84:85], v[28:29]
    v_pk_mul_f32 v[86:87], v[86:87], v[30:31]
    v_pk_mul_f32 v[88:89], v[88:89], v[32:33]
    v_pk_mul_f32 v[90:91], v[90:91], v[34:35]
    v_cvt_pk_bf16_f32 v20, v84, v85
    v_cvt_pk_bf16_f32 v21, v86, v87
    v_cvt_pk_bf16_f32 v22, v88, v89
    v_cvt_pk_bf16_f32 v23, v90, v91
    ds_write_b128 v234, v[20:23] offset:3072
    v_pk_add_f32 v[236:237], v[236:237], v[84:85]
    v_pk_fma_f32 v[244:245], v[84:85], v[84:85], v[244:245]
    v_pk_add_f32 v[238:239], v[238:239], v[88:89]
    v_pk_fma_f32 v[246:247], v[88:89], v[88:89], v[246:247]
    v_pk_add_f32 v[236:237], v[236:237], v[86:87]
    v_pk_fma_f32 v[244:245], v[86:87], v[86:87], v[244:245]
    v_pk_add_f32 v[238:239], v[238:239], v[90:91]
    v_pk_fma_f32 v[246:247], v[90:91], v[90:91], v[246:247]
    v_pk_mul_f32 v[28:29], v[92:93], v[92:93]
    v_pk_mul_f32 v[30:31], v[94:95], v[94:95]
    v_pk_mul_f32 v[32:33], v[96:97], v[96:97]
    v_pk_mul_f32 v[34:35], v[98:99], v[98:99]
    v_pk_fma_f32 v[28:29], v[28:29], v[230:231], v[228:229]
    v_pk_fma_f32 v[30:31], v[30:31], v[230:231], v[228:229]
    v_pk_fma_f32 v[32:33], v[32:33], v[230:231], v[228:229]
    v_pk_fma_f32 v[34:35], v[34:35], v[230:231], v[228:229]
    v_pk_mul_f32 v[28:29], v[28:29], v[92:93]
    v_pk_mul_f32 v[30:31], v[30:31], v[94:95]
    v_pk_mul_f32 v[32:33], v[32:33], v[96:97]
    v_pk_mul_f32 v[34:35], v[34:35], v[98:99]
    v_exp_f32 v28, v28
    v_exp_f32 v29, v29
    v_exp_f32 v30, v30
    v_exp_f32 v31, v31
    v_exp_f32 v32, v32
    v_exp_f32 v33, v33
    v_exp_f32 v34, v34
    v_exp_f32 v35, v35
    v_pk_add_f32 v[28:29], v[28:29], v[232:233]
    v_pk_add_f32 v[30:31], v[30:31], v[232:233]
    v_pk_add_f32 v[32:33], v[32:33], v[232:233]
    v_pk_add_f32 v[34:35], v[34:35], v[232:233]
    v_rcp_f32 v28, v28
    v_rcp_f32 v29, v29
    v_rcp_f32 v30, v30
    v_rcp_f32 v31, v31
    v_rcp_f32 v32, v32
    v_rcp_f32 v33, v33
    v_rcp_f32 v34, v34
    v_rcp_f32 v35, v35
    v_pk_mul_f32 v[92:93], v[92:93], v[28:29]
    v_pk_mul_f32 v[94:95], v[94:95], v[30:31]
    v_pk_mul_f32 v[96:97], v[96:97], v[32:33]
    v_pk_mul_f32 v[98:99], v[98:99], v[34:35]
    v_cvt_pk_bf16_f32 v24, v92, v93
    v_cvt_pk_bf16_f32 v25, v94, v95
    v_cvt_pk_bf16_f32 v26, v96, v97
    v_cvt_pk_bf16_f32 v27, v98, v99
    ds_write_b128 v234, v[24:27] offset:10240
    v_pk_add_f32 v[240:241], v[240:241], v[92:93]
    v_pk_fma_f32 v[248:249], v[92:93], v[92:93], v[248:249]
    v_pk_add_f32 v[242:243], v[242:243], v[96:97]
    v_pk_fma_f32 v[250:251], v[96:97], v[96:97], v[250:251]
    v_pk_add_f32 v[240:241], v[240:241], v[94:95]
    v_pk_fma_f32 v[248:249], v[94:95], v[94:95], v[248:249]
    v_pk_add_f32 v[242:243], v[242:243], v[98:99]
    v_pk_fma_f32 v[250:251], v[98:99], v[98:99], v[250:251]
    v_pk_mul_f32 v[28:29], v[100:101], v[100:101]
    v_pk_mul_f32 v[30:31], v[102:103], v[102:103]
    v_pk_mul_f32 v[32:33], v[104:105], v[104:105]
    v_pk_mul_f32 v[34:35], v[106:107], v[106:107]
    v_pk_fma_f32 v[28:29], v[28:29], v[230:231], v[228:229]
    v_pk_fma_f32 v[30:31], v[30:31], v[230:231], v[228:229]
    v_pk_fma_f32 v[32:33], v[32:33], v[230:231], v[228:229]
    v_pk_fma_f32 v[34:35], v[34:35], v[230:231], v[228:229]
    v_pk_mul_f32 v[28:29], v[28:29], v[100:101]
    v_pk_mul_f32 v[30:31], v[30:31], v[102:103]
    v_pk_mul_f32 v[32:33], v[32:33], v[104:105]
    v_pk_mul_f32 v[34:35], v[34:35], v[106:107]
    v_exp_f32 v28, v28
    v_exp_f32 v29, v29
    v_mfma_f32_16x16x32_bf16 v[84:87], v[252:255], v[252:255], 0
    v_exp_f32 v30, v30
    v_exp_f32 v31, v31
    v_exp_f32 v32, v32
    v_exp_f32 v33, v33
    v_exp_f32 v34, v34
    v_exp_f32 v35, v35
    v_pk_add_f32 v[28:29], v[28:29], v[232:233]
    v_pk_add_f32 v[30:31], v[30:31], v[232:233]
    v_pk_add_f32 v[32:33], v[32:33], v[232:233]
    v_pk_add_f32 v[34:35], v[34:35], v[232:233]
    v_rcp_f32 v28, v28
    v_rcp_f32 v29, v29
    v_mfma_f32_16x16x32_bf16 v[88:91], v[252:255], v[252:255], 0
    v_rcp_f32 v30, v30
    v_rcp_f32 v31, v31
    v_rcp_f32 v32, v32
    v_rcp_f32 v33, v33
    v_rcp_f32 v34, v34
    v_rcp_f32 v35, v35
    v_pk_mul_f32 v[100:101], v[100:101], v[28:29]
    v_pk_mul_f32 v[102:103], v[102:103], v[30:31]
    v_pk_mul_f32 v[104:105], v[104:105], v[32:33]
    v_pk_mul_f32 v[106:107], v[106:107], v[34:35]
    v_cvt_pk_bf16_f32 v20, v100, v101
    v_cvt_pk_bf16_f32 v21, v102, v103
    v_cvt_pk_bf16_f32 v22, v104, v105
    v_cvt_pk_bf16_f32 v23, v106, v107
    ds_write_b128 v234, v[20:23] offset:4096
    v_pk_add_f32 v[236:237], v[236:237], v[100:101]
    v_pk_fma_f32 v[244:245], v[100:101], v[100:101], v[244:245]
    v_pk_add_f32 v[238:239], v[238:239], v[104:105]
    v_pk_fma_f32 v[246:247], v[104:105], v[104:105], v[246:247]
    v_pk_add_f32 v[236:237], v[236:237], v[102:103]
    v_pk_fma_f32 v[244:245], v[102:103], v[102:103], v[244:245]
    v_pk_add_f32 v[238:239], v[238:239], v[106:107]
    v_pk_fma_f32 v[246:247], v[106:107], v[106:107], v[246:247]
    v_pk_mul_f32 v[28:29], v[108:109], v[108:109]
    v_pk_mul_f32 v[30:31], v[110:111], v[110:111]
    v_pk_mul_f32 v[32:33], v[112:113], v[112:113]
    v_pk_mul_f32 v[34:35], v[114:115], v[114:115]
    v_pk_fma_f32 v[28:29], v[28:29], v[230:231], v[228:229]
    v_pk_fma_f32 v[30:31], v[30:31], v[230:231], v[228:229]
    v_pk_fma_f32 v[32:33], v[32:33], v[230:231], v[228:229]
    v_pk_fma_f32 v[34:35], v[34:35], v[230:231], v[228:229]
    v_pk_mul_f32 v[28:29], v[28:29], v[108:109]
    v_pk_mul_f32 v[30:31], v[30:31], v[110:111]
    v_pk_mul_f32 v[32:33], v[32:33], v[112:113]
    v_pk_mul_f32 v[34:35], v[34:35], v[114:115]
    v_exp_f32 v28, v28
    v_exp_f32 v29, v29
    v_exp_f32 v30, v30
    v_exp_f32 v31, v31
    v_exp_f32 v32, v32
    v_exp_f32 v33, v33
    v_exp_f32 v34, v34
    v_exp_f32 v35, v35
    v_pk_add_f32 v[28:29], v[28:29], v[232:233]
    v_pk_add_f32 v[30:31], v[30:31], v[232:233]
    v_pk_add_f32 v[32:33], v[32:33], v[232:233]
    v_pk_add_f32 v[34:35], v[34:35], v[232:233]
    v_rcp_f32 v28, v28
    v_rcp_f32 v29, v29
    v_rcp_f32 v30, v30
    v_rcp_f32 v31, v31
    v_rcp_f32 v32, v32
    v_rcp_f32 v33, v33
    v_rcp_f32 v34, v34
    v_rcp_f32 v35, v35
    v_pk_mul_f32 v[108:109], v[108:109], v[28:29]
    v_pk_mul_f32 v[110:111], v[110:111], v[30:31]
    v_pk_mul_f32 v[112:113], v[112:113], v[32:33]
    v_pk_mul_f32 v[114:115], v[114:115], v[34:35]
    v_cvt_pk_bf16_f32 v24, v108, v109
    v_cvt_pk_bf16_f32 v25, v110, v111
    v_cvt_pk_bf16_f32 v26, v112, v113
    v_cvt_pk_bf16_f32 v27, v114, v115
    ds_write_b128 v234, v[24:27] offset:11264
    v_pk_add_f32 v[240:241], v[240:241], v[108:109]
    v_pk_fma_f32 v[248:249], v[108:109], v[108:109], v[248:249]
    v_pk_add_f32 v[242:243], v[242:243], v[112:113]
    v_pk_fma_f32 v[250:251], v[112:113], v[112:113], v[250:251]
    v_pk_add_f32 v[240:241], v[240:241], v[110:111]
    v_pk_fma_f32 v[248:249], v[110:111], v[110:111], v[248:249]
    v_pk_add_f32 v[242:243], v[242:243], v[114:115]
    v_pk_fma_f32 v[250:251], v[114:115], v[114:115], v[250:251]
    v_pk_mul_f32 v[28:29], v[116:117], v[116:117]
    v_pk_mul_f32 v[30:31], v[118:119], v[118:119]
    v_pk_mul_f32 v[32:33], v[120:121], v[120:121]
    v_pk_mul_f32 v[34:35], v[122:123], v[122:123]
    v_pk_fma_f32 v[28:29], v[28:29], v[230:231], v[228:229]
    v_pk_fma_f32 v[30:31], v[30:31], v[230:231], v[228:229]
    v_pk_fma_f32 v[32:33], v[32:33], v[230:231], v[228:229]
    v_pk_fma_f32 v[34:35], v[34:35], v[230:231], v[228:229]
    v_pk_mul_f32 v[28:29], v[28:29], v[116:117]
    v_pk_mul_f32 v[30:31], v[30:31], v[118:119]
    v_pk_mul_f32 v[32:33], v[32:33], v[120:121]
    v_pk_mul_f32 v[34:35], v[34:35], v[122:123]
    v_exp_f32 v28, v28
    v_exp_f32 v29, v29
    v_exp_f32 v30, v30
    v_exp_f32 v31, v31
    v_exp_f32 v32, v32
    v_exp_f32 v33, v33
    v_exp_f32 v34, v34
    v_exp_f32 v35, v35
    v_pk_add_f32 v[28:29], v[28:29], v[232:233]
    v_pk_add_f32 v[30:31], v[30:31], v[232:233]
    v_pk_add_f32 v[32:33], v[32:33], v[232:233]
    v_pk_add_f32 v[34:35], v[34:35], v[232:233]
    v_rcp_f32 v28, v28
    v_rcp_f32 v29, v29
    v_rcp_f32 v30, v30
    v_rcp_f32 v31, v31
    v_rcp_f32 v32, v32
    v_rcp_f32 v33, v33
    v_rcp_f32 v34, v34
    v_rcp_f32 v35, v35
    v_pk_mul_f32 v[116:117], v[116:117], v[28:29]
    v_pk_mul_f32 v[118:119], v[118:119], v[30:31]
    v_pk_mul_f32 v[120:121], v[120:121], v[32:33]
    v_pk_mul_f32 v[122:123], v[122:123], v[34:35]
    v_cvt_pk_bf16_f32 v20, v116, v117
    v_cvt_pk_bf16_f32 v21, v118, v119
    v_cvt_pk_bf16_f32 v22, v120, v121
    v_cvt_pk_bf16_f32 v23, v122, v123
    ds_write_b128 v234, v[20:23] offset:5120
    v_pk_add_f32 v[236:237], v[236:237], v[116:117]
    v_pk_fma_f32 v[244:245], v[116:117], v[116:117], v[244:245]
    v_pk_add_f32 v[238:239], v[238:239], v[120:121]
    v_pk_fma_f32 v[246:247], v[120:121], v[120:121], v[246:247]
    v_pk_add_f32 v[236:237], v[236:237], v[118:119]
    v_pk_fma_f32 v[244:245], v[118:119], v[118:119], v[244:245]
    v_pk_add_f32 v[238:239], v[238:239], v[122:123]
    v_pk_fma_f32 v[246:247], v[122:123], v[122:123], v[246:247]
    v_pk_mul_f32 v[28:29], v[124:125], v[124:125]
    v_pk_mul_f32 v[30:31], v[126:127], v[126:127]
    v_pk_mul_f32 v[32:33], v[128:129], v[128:129]
    v_pk_mul_f32 v[34:35], v[130:131], v[130:131]
    v_pk_fma_f32 v[28:29], v[28:29], v[230:231], v[228:229]
    v_pk_fma_f32 v[30:31], v[30:31], v[230:231], v[228:229]
    v_pk_fma_f32 v[32:33], v[32:33], v[230:231], v[228:229]
    v_pk_fma_f32 v[34:35], v[34:35], v[230:231], v[228:229]
    v_pk_mul_f32 v[28:29], v[28:29], v[124:125]
    v_pk_mul_f32 v[30:31], v[30:31], v[126:127]
    v_pk_mul_f32 v[32:33], v[32:33], v[128:129]
    v_pk_mul_f32 v[34:35], v[34:35], v[130:131]
    v_exp_f32 v28, v28
    v_exp_f32 v29, v29
    v_exp_f32 v30, v30
    v_exp_f32 v31, v31
    v_exp_f32 v32, v32
    v_exp_f32 v33, v33
    v_exp_f32 v34, v34
    v_exp_f32 v35, v35
    v_pk_add_f32 v[28:29], v[28:29], v[232:233]
    v_pk_add_f32 v[30:31], v[30:31], v[232:233]
    v_pk_add_f32 v[32:33], v[32:33], v[232:233]
    v_pk_add_f32 v[34:35], v[34:35], v[232:233]
    v_rcp_f32 v28, v28
    v_rcp_f32 v29, v29
    v_rcp_f32 v30, v30
    v_rcp_f32 v31, v31
    v_rcp_f32 v32, v32
    v_rcp_f32 v33, v33
    v_rcp_f32 v34, v34
    v_rcp_f32 v35, v35
    v_pk_mul_f32 v[124:125], v[124:125], v[28:29]
    v_pk_mul_f32 v[126:127], v[126:127], v[30:31]
    v_pk_mul_f32 v[128:129], v[128:129], v[32:33]
    v_pk_mul_f32 v[130:131], v[130:131], v[34:35]
    v_cvt_pk_bf16_f32 v24, v124, v125
    v_cvt_pk_bf16_f32 v25, v126, v127
    v_cvt_pk_bf16_f32 v26, v128, v129
    v_cvt_pk_bf16_f32 v27, v130, v131
    ds_write_b128 v234, v[24:27] offset:12288
    v_pk_add_f32 v[240:241], v[240:241], v[124:125]
    v_pk_fma_f32 v[248:249], v[124:125], v[124:125], v[248:249]
    v_pk_add_f32 v[242:243], v[242:243], v[128:129]
    v_pk_fma_f32 v[250:251], v[128:129], v[128:129], v[250:251]
    v_pk_add_f32 v[240:241], v[240:241], v[126:127]
    v_pk_fma_f32 v[248:249], v[126:127], v[126:127], v[248:249]
    v_pk_add_f32 v[242:243], v[242:243], v[130:131]
    v_pk_fma_f32 v[250:251], v[130:131], v[130:131], v[250:251]
    v_pk_mul_f32 v[28:29], v[132:133], v[132:133]
    v_pk_mul_f32 v[30:31], v[134:135], v[134:135]
    v_pk_mul_f32 v[32:33], v[136:137], v[136:137]
    v_pk_mul_f32 v[34:35], v[138:139], v[138:139]
    v_pk_fma_f32 v[28:29], v[28:29], v[230:231], v[228:229]
    v_pk_fma_f32 v[30:31], v[30:31], v[230:231], v[228:229]
    v_pk_fma_f32 v[32:33], v[32:33], v[230:231], v[228:229]
    v_pk_fma_f32 v[34:35], v[34:35], v[230:231], v[228:229]
    v_pk_mul_f32 v[28:29], v[28:29], v[132:133]
    v_pk_mul_f32 v[30:31], v[30:31], v[134:135]
    v_pk_mul_f32 v[32:33], v[32:33], v[136:137]
    v_pk_mul_f32 v[34:35], v[34:35], v[138:139]
    v_exp_f32 v28, v28
    v_exp_f32 v29, v29
    v_exp_f32 v30, v30
    v_exp_f32 v31, v31
    v_exp_f32 v32, v32
    v_exp_f32 v33, v33
    v_exp_f32 v34, v34
    v_exp_f32 v35, v35
    v_pk_add_f32 v[28:29], v[28:29], v[232:233]
    v_pk_add_f32 v[30:31], v[30:31], v[232:233]
    v_pk_add_f32 v[32:33], v[32:33], v[232:233]
    v_pk_add_f32 v[34:35], v[34:35], v[232:233]
    v_rcp_f32 v28, v28
    v_rcp_f32 v29, v29
    v_rcp_f32 v30, v30
    v_rcp_f32 v31, v31
    v_rcp_f32 v32, v32
    v_rcp_f32 v33, v33
    v_rcp_f32 v34, v34
    v_rcp_f32 v35, v35
    v_pk_mul_f32 v[132:133], v[132:133], v[28:29]
    v_pk_mul_f32 v[134:135], v[134:135], v[30:31]
    v_pk_mul_f32 v[136:137], v[136:137], v[32:33]
    v_pk_mul_f32 v[138:139], v[138:139], v[34:35]
    v_cvt_pk_bf16_f32 v20, v132, v133
    v_cvt_pk_bf16_f32 v21, v134, v135
    v_cvt_pk_bf16_f32 v22, v136, v137
    v_cvt_pk_bf16_f32 v23, v138, v139
    ds_write_b128 v234, v[20:23] offset:6144
    v_pk_add_f32 v[236:237], v[236:237], v[132:133]
    v_pk_fma_f32 v[244:245], v[132:133], v[132:133], v[244:245]
    v_pk_add_f32 v[238:239], v[238:239], v[136:137]
    v_pk_fma_f32 v[246:247], v[136:137], v[136:137], v[246:247]
    v_pk_add_f32 v[236:237], v[236:237], v[134:135]
    v_pk_fma_f32 v[244:245], v[134:135], v[134:135], v[244:245]
    v_pk_add_f32 v[238:239], v[238:239], v[138:139]
    v_pk_fma_f32 v[246:247], v[138:139], v[138:139], v[246:247]
    v_pk_mul_f32 v[28:29], v[140:141], v[140:141]
    v_pk_mul_f32 v[30:31], v[142:143], v[142:143]
    v_pk_mul_f32 v[32:33], v[144:145], v[144:145]
    v_pk_mul_f32 v[34:35], v[146:147], v[146:147]
    v_pk_fma_f32 v[28:29], v[28:29], v[230:231], v[228:229]
    v_pk_fma_f32 v[30:31], v[30:31], v[230:231], v[228:229]
    v_pk_fma_f32 v[32:33], v[32:33], v[230:231], v[228:229]
    v_pk_fma_f32 v[34:35], v[34:35], v[230:231], v[228:229]
    v_pk_mul_f32 v[28:29], v[28:29], v[140:141]
    v_pk_mul_f32 v[30:31], v[30:31], v[142:143]
    v_pk_mul_f32 v[32:33], v[32:33], v[144:145]
    v_pk_mul_f32 v[34:35], v[34:35], v[146:147]
    v_exp_f32 v28, v28
    v_exp_f32 v29, v29
    v_mfma_f32_16x16x32_bf16 v[120:123], v[252:255], v[252:255], 0
    v_exp_f32 v30, v30
    v_exp_f32 v31, v31
    v_exp_f32 v32, v32
    v_exp_f32 v33, v33
    v_exp_f32 v34, v34
    v_exp_f32 v35, v35
    v_pk_add_f32 v[28:29], v[28:29], v[232:233]
    v_pk_add_f32 v[30:31], v[30:31], v[232:233]
    v_pk_add_f32 v[32:33], v[32:33], v[232:233]
    v_pk_add_f32 v[34:35], v[34:35], v[232:233]
    v_rcp_f32 v28, v28
    v_rcp_f32 v29, v29
    v_rcp_f32 v30, v30
    v_rcp_f32 v31, v31
    v_rcp_f32 v32, v32
    v_rcp_f32 v33, v33
    v_rcp_f32 v34, v34
    v_rcp_f32 v35, v35
    v_pk_mul_f32 v[140:141], v[140:141], v[28:29]
    v_pk_mul_f32 v[142:143], v[142:143], v[30:31]
    v_pk_mul_f32 v[144:145], v[144:145], v[32:33]
    v_pk_mul_f32 v[146:147], v[146:147], v[34:35]
    v_cvt_pk_bf16_f32 v24, v140, v141
    v_cvt_pk_bf16_f32 v25, v142, v143
    v_cvt_pk_bf16_f32 v26, v144, v145
    v_cvt_pk_bf16_f32 v27, v146, v147
    ds_write_b128 v234, v[24:27] offset:13312
    v_pk_add_f32 v[240:241], v[240:241], v[140:141]
    v_pk_fma_f32 v[248:249], v[140:141], v[140:141], v[248:249]
    v_pk_add_f32 v[242:243], v[242:243], v[144:145]
    v_pk_fma_f32 v[250:251], v[144:145], v[144:145], v[250:251]
    v_pk_add_f32 v[240:241], v[240:241], v[142:143]
    v_pk_fma_f32 v[248:249], v[142:143], v[142:143], v[248:249]
    v_pk_add_f32 v[242:243], v[242:243], v[146:147]
    v_pk_fma_f32 v[250:251], v[146:147], v[146:147], v[250:251]
    s_bitcmp0_b32 s4, 0
    s_cbranch_scc1 F_nostat
    v_add_f32 v236, v236, v237
    v_add_f32 v238, v238, v239
    v_add_f32 v240, v240, v241
    v_add_f32 v242, v242, v243
    v_add_f32 v244, v244, v245
    v_add_f32 v246, v246, v247
    v_add_f32 v248, v248, v249
    v_add_f32 v250, v250, v251
    v_permlane32_swap_b32 v236, v240
    v_permlane32_swap_b32 v238, v242
    v_permlane32_swap_b32 v244, v248
    v_permlane32_swap_b32 v246, v250
    v_add_f32 v236, v236, v240
    v_add_f32 v238, v238, v242
    v_add_f32 v244, v244, v248
    v_add_f32 v246, v246, v250
    s_lshl_b32 s64, s3, 4
    s_add_u32 s64, s64, s4
    s_add_u32 s64, s64, s7
    s_lshl_b32 s64, s64, 10
    s_lshl_b32 s65, s6, 9
    v_permlane16_swap_b32 v236, v238
    v_permlane16_swap_b32 v244, v246
    s_add_u32 s64, s64, s65
    s_add_u32 s64, s64, 4455424
    v_and_b32 v2, 15, v0
    v_bfe_u32 v3, v0, 4, 1
    v_lshl_add_u32 v2, v2, 1, v3
    v_and_b32 v3, 32, v0
    v_add_lshl_u32 v2, v2, v3, 3
    v_add_f32 v28, v236, v238
    v_add_f32 v29, v244, v246
    v_min_u32 v28, -2, v28
    v_min_u32 v29, -2, v29
    buffer_store_dwordx2 v[28:29], v2, s[24:27], s64 offen sc1
F_nostat:
    s_mov_b32 s56, 94208
    s_mov_b32 s58, 0
    s_waitcnt lgkmcnt(0)
    s_barrier
    ds_read_b128 v[92:95], v218 offset:0
    ds_read_b128 v[96:99], v218 offset:1024
    ds_read_b128 v[108:111], v218 offset:2048
    ds_read_b128 v[112:115], v218 offset:3072
    s_mov_b32 s6, s5
    s_cmp_ge_u32 s6, 2
    s_cbranch_scc1 F_src1
    s_and_b32 s7, s6, 1
    s_lshl_b32 s62, s3, 19
    s_lshl_b32 s64, s7, 18
    s_add_u32 s62, s62, s64
    s_add_u32 s62, s62, 512
    s_lshl_b32 s7, s7, 13
    s_mov_b32 s59, 0
    s_branch F_src2
F_src1:
    s_and_b32 s7, s6, 1
    s_lshl_b32 s62, s4, 6
    s_add_u32 s62, s62, s7
    s_lshl_b32 s62, s62, 13
    s_add_u32 s62, s62, 5308416
    s_mul_i32 s7, s7, 7168
    s_add_u32 s7, s7, 16384
    s_mov_b32 s59, 0
F_src2:
    s_waitcnt lgkmcnt(0)
    v_mfma_f32_32x32x16_bf16 v[20:35], v[92:95], v[4:7], 0
    v_mfma_f32_32x32x16_bf16 v[20:35], v[96:99], v[8:11], v[20:35]
    s_nop 9
    s_nop 0
    s_branch F_in2
    .p2align 6
F_c2:
    v_exp_f32 v20, v20
    v_smfmac_f32_16x16x64_bf16 v[88:91], v[212:215], v[36:43], v216
    ds_read_b128 v[92:95], v218 offset:0
    v_exp_f32 v21, v21
    v_smfmac_f32_32x32x32_bf16 v[68:83], v[112:115], v[44:51], v216
    ds_read_b128 v[96:99], v218 offset:1024
    v_exp_f32 v22, v22
    v_exp_f32 v23, v23
    v_exp_f32 v24, v24
    v_smfmac_f32_16x16x64_bf16 v[88:91], v[212:215], v[44:51], v216
    ds_read_b128 v[108:111], v218 offset:2048
    v_exp_f32 v25, v25
    v_mfma_f32_32x32x16_bf16 v[36:51], v[100:103], v[12:15], 0
    v_exp_f32 v26, v26
    v_exp_f32 v27, v27
    v_exp_f32 v28, v28
    v_exp_f32 v29, v29
    v_mfma_f32_32x32x16_bf16 v[36:51], v[104:107], v[16:19], v[36:51]
    v_exp_f32 v30, v30
    v_exp_f32 v31, v31
    v_exp_f32 v32, v32
    v_exp_f32 v33, v33
    v_smfmac_f32_32x32x32_bf16 v[52:67], v[116:119], v[20:27], v216
    ds_read_b128 v[112:115], v218 offset:3072
    v_exp_f32 v34, v34
    v_exp_f32 v35, v35
    v_exp_f32 v36, v36
    v_smfmac_f32_16x16x64_bf16 v[84:87], v[212:215], v[20:27], v216
    v_exp_f32 v37, v37
    v_smfmac_f32_32x32x32_bf16 v[52:67], v[120:123], v[28:35], v216
    v_exp_f32 v38, v38
    v_exp_f32 v39, v39
    v_exp_f32 v40, v40
    v_smfmac_f32_16x16x64_bf16 v[84:87], v[212:215], v[28:35], v216
    s_waitcnt lgkmcnt(0)
    v_exp_f32 v41, v41
    v_mfma_f32_32x32x16_bf16 v[20:35], v[92:95], v[4:7], 0
    v_exp_f32 v42, v42
    v_exp_f32 v43, v43
    v_exp_f32 v44, v44
    v_exp_f32 v45, v45
    v_mfma_f32_32x32x16_bf16 v[20:35], v[96:99], v[8:11], v[20:35]
    v_exp_f32 v46, v46
    v_exp_f32 v47, v47
    v_exp_f32 v48, v48
    v_exp_f32 v49, v49
    v_smfmac_f32_32x32x32_bf16 v[68:83], v[116:119], v[36:43], v216
    v_exp_f32 v50, v50
    v_exp_f32 v51, v51
F_in2:
    v_exp_f32 v20, v20
    v_smfmac_f32_16x16x64_bf16 v[88:91], v[212:215], v[36:43], v216
    ds_read_b128 v[100:103], v218 offset:4096
    v_exp_f32 v21, v21
    v_smfmac_f32_32x32x32_bf16 v[68:83], v[120:123], v[44:51], v216
    ds_read_b128 v[104:107], v218 offset:5120
    v_exp_f32 v22, v22
    v_exp_f32 v23, v23
    v_exp_f32 v24, v24
    v_smfmac_f32_16x16x64_bf16 v[88:91], v[212:215], v[44:51], v216
    ds_read_b128 v[116:119], v218 offset:6144
    v_exp_f32 v25, v25
    v_mfma_f32_32x32x16_bf16 v[36:51], v[92:95], v[12:15], 0
    v_exp_f32 v26, v26
    v_exp_f32 v27, v27
    v_exp_f32 v28, v28
    v_exp_f32 v29, v29
    v_mfma_f32_32x32x16_bf16 v[36:51], v[96:99], v[16:19], v[36:51]
    v_exp_f32 v30, v30
    v_exp_f32 v31, v31
    v_exp_f32 v32, v32
    v_exp_f32 v33, v33
    v_smfmac_f32_32x32x32_bf16 v[52:67], v[108:111], v[20:27], v216
    ds_read_b128 v[120:123], v218 offset:7168
    v_exp_f32 v34, v34
    v_exp_f32 v35, v35
    v_exp_f32 v36, v36
    v_smfmac_f32_16x16x64_bf16 v[84:87], v[212:215], v[20:27], v216
    v_exp_f32 v37, v37
    v_smfmac_f32_32x32x32_bf16 v[52:67], v[112:115], v[28:35], v216
    v_exp_f32 v38, v38
    v_exp_f32 v39, v39
    v_exp_f32 v40, v40
    v_smfmac_f32_16x16x64_bf16 v[84:87], v[212:215], v[28:35], v216
    s_waitcnt lgkmcnt(0)
    v_exp_f32 v41, v41
    v_mfma_f32_32x32x16_bf16 v[20:35], v[100:103], v[4:7], 0
    v_exp_f32 v42, v42
    v_exp_f32 v43, v43
    v_exp_f32 v44, v44
    v_exp_f32 v45, v45
    v_mfma_f32_32x32x16_bf16 v[20:35], v[104:107], v[8:11], v[20:35]
    v_exp_f32 v46, v46
    v_exp_f32 v47, v47
    v_exp_f32 v48, v48
    v_exp_f32 v49, v49
    v_smfmac_f32_32x32x32_bf16 v[68:83], v[108:111], v[36:43], v216
    v_exp_f32 v50, v50
    v_exp_f32 v51, v51
    v_exp_f32 v20, v20
    v_smfmac_f32_16x16x64_bf16 v[88:91], v[212:215], v[36:43], v216
    ds_read_b128 v[92:95], v218 offset:8192
    v_exp_f32 v21, v21
    v_smfmac_f32_32x32x32_bf16 v[68:83], v[112:115], v[44:51], v216
    ds_read_b128 v[96:99], v218 offset:9216
    v_exp_f32 v22, v22
    v_exp_f32 v23, v23
    v_exp_f32 v24, v24
    v_smfmac_f32_16x16x64_bf16 v[88:91], v[212:215], v[44:51], v216
    ds_read_b128 v[108:111], v218 offset:10240
    v_exp_f32 v25, v25
    v_mfma_f32_32x32x16_bf16 v[36:51], v[100:103], v[12:15], 0
    v_exp_f32 v26, v26
    v_exp_f32 v27, v27
    v_exp_f32 v28, v28
    v_exp_f32 v29, v29
    v_mfma_f32_32x32x16_bf16 v[36:51], v[104:107], v[16:19], v[36:51]
    v_exp_f32 v30, v30
    v_exp_f32 v31, v31
    v_exp_f32 v32, v32
    v_exp_f32 v33, v33
    v_smfmac_f32_32x32x32_bf16 v[52:67], v[116:119], v[20:27], v216
    ds_read_b128 v[112:115], v218 offset:11264
    v_exp_f32 v34, v34
    v_exp_f32 v35, v35
    v_exp_f32 v36, v36
    v_smfmac_f32_16x16x64_bf16 v[84:87], v[212:215], v[20:27], v216
    v_exp_f32 v37, v37
    v_smfmac_f32_32x32x32_bf16 v[52:67], v[120:123], v[28:35], v216
    v_exp_f32 v38, v38
    v_exp_f32 v39, v39
    v_exp_f32 v40, v40
    v_smfmac_f32_16x16x64_bf16 v[84:87], v[212:215], v[28:35], v216
    s_waitcnt lgkmcnt(0)
    v_exp_f32 v41, v41
    v_mfma_f32_32x32x16_bf16 v[20:35], v[92:95], v[4:7], 0
    v_exp_f32 v42, v42
    v_exp_f32 v43, v43
    v_exp_f32 v44, v44
    v_exp_f32 v45, v45
    v_mfma_f32_32x32x16_bf16 v[20:35], v[96:99], v[8:11], v[20:35]
    v_exp_f32 v46, v46
    v_exp_f32 v47, v47
    v_exp_f32 v48, v48
    v_exp_f32 v49, v49
    v_smfmac_f32_32x32x32_bf16 v[68:83], v[116:119], v[36:43], v216
    v_exp_f32 v50, v50
    v_exp_f32 v51, v51
    v_exp_f32 v20, v20
    v_smfmac_f32_16x16x64_bf16 v[88:91], v[212:215], v[36:43], v216
    ds_read_b128 v[100:103], v218 offset:12288
    v_exp_f32 v21, v21
    v_smfmac_f32_32x32x32_bf16 v[68:83], v[120:123], v[44:51], v216
    ds_read_b128 v[104:107], v218 offset:13312
    v_exp_f32 v22, v22
    v_exp_f32 v23, v23
    v_exp_f32 v24, v24
    v_smfmac_f32_16x16x64_bf16 v[88:91], v[212:215], v[44:51], v216
    ds_read_b128 v[116:119], v218 offset:14336
    v_exp_f32 v25, v25
    v_mfma_f32_32x32x16_bf16 v[36:51], v[92:95], v[12:15], 0
    v_exp_f32 v26, v26
    v_exp_f32 v27, v27
    v_exp_f32 v28, v28
    v_exp_f32 v29, v29
    v_mfma_f32_32x32x16_bf16 v[36:51], v[96:99], v[16:19], v[36:51]
    v_exp_f32 v30, v30
    v_exp_f32 v31, v31
    v_exp_f32 v32, v32
    v_exp_f32 v33, v33
    v_smfmac_f32_32x32x32_bf16 v[52:67], v[108:111], v[20:27], v216
    ds_read_b128 v[120:123], v218 offset:15360
    v_exp_f32 v34, v34
    v_exp_f32 v35, v35
    v_exp_f32 v36, v36
    v_smfmac_f32_16x16x64_bf16 v[84:87], v[212:215], v[20:27], v216
    v_exp_f32 v37, v37
    v_smfmac_f32_32x32x32_bf16 v[52:67], v[112:115], v[28:35], v216
    v_exp_f32 v38, v38
    v_exp_f32 v39, v39
    v_exp_f32 v40, v40
    v_smfmac_f32_16x16x64_bf16 v[84:87], v[212:215], v[28:35], v216
    s_waitcnt lgkmcnt(0)
    v_exp_f32 v41, v41
    v_mfma_f32_32x32x16_bf16 v[20:35], v[100:103], v[4:7], 0
    v_exp_f32 v42, v42
    v_exp_f32 v43, v43
    v_exp_f32 v44, v44
    v_exp_f32 v45, v45
    v_mfma_f32_32x32x16_bf16 v[20:35], v[104:107], v[8:11], v[20:35]
    v_exp_f32 v46, v46
    v_exp_f32 v47, v47
    v_exp_f32 v48, v48
    v_exp_f32 v49, v49
    v_smfmac_f32_32x32x32_bf16 v[68:83], v[108:111], v[36:43], v216
    v_exp_f32 v50, v50
    v_exp_f32 v51, v51
    v_exp_f32 v20, v20
    v_smfmac_f32_16x16x64_bf16 v[88:91], v[212:215], v[36:43], v216
    ds_read_b128 v[92:95], v218 offset:16384
    v_exp_f32 v21, v21
    v_smfmac_f32_32x32x32_bf16 v[68:83], v[112:115], v[44:51], v216
    ds_read_b128 v[96:99], v218 offset:17408
    v_exp_f32 v22, v22
    v_exp_f32 v23, v23
    v_exp_f32 v24, v24
    v_smfmac_f32_16x16x64_bf16 v[88:91], v[212:215], v[44:51], v216
    ds_read_b128 v[108:111], v218 offset:18432
    v_exp_f32 v25, v25
    v_mfma_f32_32x32x16_bf16 v[36:51], v[100:103], v[12:15], 0
    v_exp_f32 v26, v26
    v_exp_f32 v27, v27
    v_exp_f32 v28, v28
    v_exp_f32 v29, v29
    v_mfma_f32_32x32x16_bf16 v[36:51], v[104:107], v[16:19], v[36:51]
    v_exp_f32 v30, v30
    v_exp_f32 v31, v31
    v_exp_f32 v32, v32
    v_exp_f32 v33, v33
    v_smfmac_f32_32x32x32_bf16 v[52:67], v[116:119], v[20:27], v216
    ds_read_b128 v[112:115], v218 offset:19456
    v_exp_f32 v34, v34
    v_exp_f32 v35, v35
    v_exp_f32 v36, v36
    v_smfmac_f32_16x16x64_bf16 v[84:87], v[212:215], v[20:27], v216
    v_exp_f32 v37, v37
    v_smfmac_f32_32x32x32_bf16 v[52:67], v[120:123], v[28:35], v216
    v_exp_f32 v38, v38
    v_exp_f32 v39, v39
    v_exp_f32 v40, v40
    v_smfmac_f32_16x16x64_bf16 v[84:87], v[212:215], v[28:35], v216
    s_waitcnt lgkmcnt(0)
    v_exp_f32 v41, v41
    v_mfma_f32_32x32x16_bf16 v[20:35], v[92:95], v[4:7], 0
    v_exp_f32 v42, v42
    v_exp_f32 v43, v43
    v_exp_f32 v44, v44
    v_exp_f32 v45, v45
    v_mfma_f32_32x32x16_bf16 v[20:35], v[96:99], v[8:11], v[20:35]
    v_exp_f32 v46, v46
    v_exp_f32 v47, v47
    v_exp_f32 v48, v48
    v_exp_f32 v49, v49
    v_smfmac_f32_32x32x32_bf16 v[68:83], v[116:119], v[36:43], v216
    v_exp_f32 v50, v50
    v_exp_f32 v51, v51
    v_exp_f32 v20, v20
    v_smfmac_f32_16x16x64_bf16 v[88:91], v[212:215], v[36:43], v216
    ds_read_b128 v[100:103], v218 offset:20480
    v_exp_f32 v21, v21
    v_smfmac_f32_32x32x32_bf16 v[68:83], v[120:123], v[44:51], v216
    ds_read_b128 v[104:107], v218 offset:21504
    v_exp_f32 v22, v22
    v_exp_f32 v23, v23
    v_exp_f32 v24, v24
    v_smfmac_f32_16x16x64_bf16 v[88:91], v[212:215], v[44:51], v216
    ds_read_b128 v[116:119], v218 offset:22528
    v_exp_f32 v25, v25
    v_mfma_f32_32x32x16_bf16 v[36:51], v[92:95], v[12:15], 0
    v_exp_f32 v26, v26
    v_exp_f32 v27, v27
    v_exp_f32 v28, v28
    v_exp_f32 v29, v29
    v_mfma_f32_32x32x16_bf16 v[36:51], v[96:99], v[16:19], v[36:51]
    v_exp_f32 v30, v30
    v_exp_f32 v31, v31
    v_exp_f32 v32, v32
    v_exp_f32 v33, v33
    v_smfmac_f32_32x32x32_bf16 v[52:67], v[108:111], v[20:27], v216
    ds_read_b128 v[120:123], v218 offset:23552
    v_exp_f32 v34, v34
    v_exp_f32 v35, v35
    v_exp_f32 v36, v36
    v_smfmac_f32_16x16x64_bf16 v[84:87], v[212:215], v[20:27], v216
    v_exp_f32 v37, v37
    v_smfmac_f32_32x32x32_bf16 v[52:67], v[112:115], v[28:35], v216
    v_exp_f32 v38, v38
    v_exp_f32 v39, v39
    v_exp_f32 v40, v40
    v_smfmac_f32_16x16x64_bf16 v[84:87], v[212:215], v[28:35], v216
    s_waitcnt lgkmcnt(0)
    v_exp_f32 v41, v41
    v_mfma_f32_32x32x16_bf16 v[20:35], v[100:103], v[4:7], 0
    v_exp_f32 v42, v42
    v_exp_f32 v43, v43
    v_exp_f32 v44, v44
    v_exp_f32 v45, v45
    v_mfma_f32_32x32x16_bf16 v[20:35], v[104:107], v[8:11], v[20:35]
    v_exp_f32 v46, v46
    v_exp_f32 v47, v47
    v_exp_f32 v48, v48
    v_exp_f32 v49, v49
    v_smfmac_f32_32x32x32_bf16 v[68:83], v[108:111], v[36:43], v216
    v_exp_f32 v50, v50
    v_exp_f32 v51, v51
    v_exp_f32 v20, v20
    v_smfmac_f32_16x16x64_bf16 v[88:91], v[212:215], v[36:43], v216
    ds_read_b128 v[92:95], v218 offset:24576
    v_exp_f32 v21, v21
    v_smfmac_f32_32x32x32_bf16 v[68:83], v[112:115], v[44:51], v216
    ds_read_b128 v[96:99], v218 offset:25600
    v_exp_f32 v22, v22
    v_exp_f32 v23, v23
    v_exp_f32 v24, v24
    v_smfmac_f32_16x16x64_bf16 v[88:91], v[212:215], v[44:51], v216
    ds_read_b128 v[108:111], v218 offset:26624
    v_exp_f32 v25, v25
    v_mfma_f32_32x32x16_bf16 v[36:51], v[100:103], v[12:15], 0
    v_exp_f32 v26, v26
    v_exp_f32 v27, v27
    v_exp_f32 v28, v28
    v_exp_f32 v29, v29
    v_mfma_f32_32x32x16_bf16 v[36:51], v[104:107], v[16:19], v[36:51]
    v_exp_f32 v30, v30
    v_exp_f32 v31, v31
    v_exp_f32 v32, v32
    v_exp_f32 v33, v33
    v_smfmac_f32_32x32x32_bf16 v[52:67], v[116:119], v[20:27], v216
    ds_read_b128 v[112:115], v218 offset:27648
    v_exp_f32 v34, v34
    v_exp_f32 v35, v35
    v_exp_f32 v36, v36
    v_smfmac_f32_16x16x64_bf16 v[84:87], v[212:215], v[20:27], v216
    v_exp_f32 v37, v37
    v_smfmac_f32_32x32x32_bf16 v[52:67], v[120:123], v[28:35], v216
    v_exp_f32 v38, v38
    v_exp_f32 v39, v39
    v_exp_f32 v40, v40
    v_smfmac_f32_16x16x64_bf16 v[84:87], v[212:215], v[28:35], v216
    s_waitcnt lgkmcnt(0)
    v_exp_f32 v41, v41
    v_mfma_f32_32x32x16_bf16 v[20:35], v[92:95], v[4:7], 0
    v_exp_f32 v42, v42
    v_exp_f32 v43, v43
    v_exp_f32 v44, v44
    v_exp_f32 v45, v45
    v_mfma_f32_32x32x16_bf16 v[20:35], v[96:99], v[8:11], v[20:35]
    v_exp_f32 v46, v46
    v_exp_f32 v47, v47
    v_exp_f32 v48, v48
    v_exp_f32 v49, v49
    v_smfmac_f32_32x32x32_bf16 v[68:83], v[116:119], v[36:43], v216
    v_exp_f32 v50, v50
    v_exp_f32 v51, v51
    v_exp_f32 v20, v20
    v_smfmac_f32_16x16x64_bf16 v[88:91], v[212:215], v[36:43], v216
    ds_read_b128 v[100:103], v218 offset:28672
    v_exp_f32 v21, v21
    v_smfmac_f32_32x32x32_bf16 v[68:83], v[120:123], v[44:51], v216
    ds_read_b128 v[104:107], v218 offset:29696
    v_exp_f32 v22, v22
    v_exp_f32 v23, v23
    v_exp_f32 v24, v24
    v_smfmac_f32_16x16x64_bf16 v[88:91], v[212:215], v[44:51], v216
    ds_read_b128 v[116:119], v218 offset:30720
    v_exp_f32 v25, v25
    v_mfma_f32_32x32x16_bf16 v[36:51], v[92:95], v[12:15], 0
    v_exp_f32 v26, v26
    v_exp_f32 v27, v27
    v_exp_f32 v28, v28
    v_exp_f32 v29, v29
    v_mfma_f32_32x32x16_bf16 v[36:51], v[96:99], v[16:19], v[36:51]
    v_exp_f32 v30, v30
    v_exp_f32 v31, v31
    v_exp_f32 v32, v32
    v_exp_f32 v33, v33
    v_smfmac_f32_32x32x32_bf16 v[52:67], v[108:111], v[20:27], v216
    ds_read_b128 v[120:123], v218 offset:31744
    v_exp_f32 v34, v34
    v_exp_f32 v35, v35
    v_exp_f32 v36, v36
    v_smfmac_f32_16x16x64_bf16 v[84:87], v[212:215], v[20:27], v216
    s_xor_b32 s56, s56, 32768
    v_exp_f32 v37, v37
    v_smfmac_f32_32x32x32_bf16 v[52:67], v[112:115], v[28:35], v216
    s_add_u32 s58, s58, 1
    s_cmp_lt_u32 s58, 8
    v_exp_f32 v38, v38
    v_exp_f32 v39, v39
    v_exp_f32 v40, v40
    v_smfmac_f32_16x16x64_bf16 v[84:87], v[212:215], v[28:35], v216
    s_waitcnt lgkmcnt(0)
    v_exp_f32 v41, v41
    v_mfma_f32_32x32x16_bf16 v[20:35], v[100:103], v[4:7], 0
    v_add_u32 v218, s56, v1
    v_exp_f32 v42, v42
    v_exp_f32 v43, v43
    v_exp_f32 v44, v44
    v_exp_f32 v45, v45
    v_mfma_f32_32x32x16_bf16 v[20:35], v[104:107], v[8:11], v[20:35]
    v_exp_f32 v46, v46
    v_exp_f32 v47, v47
    v_exp_f32 v48, v48
    v_exp_f32 v49, v49
    v_smfmac_f32_32x32x32_bf16 v[68:83], v[108:111], v[36:43], v216
    s_barrier
    v_exp_f32 v50, v50
    v_exp_f32 v51, v51
    s_cbranch_scc1 F_c2
    s_setprio 2
    v_exp_f32 v20, v20
    v_smfmac_f32_16x16x64_bf16 v[88:91], v[212:215], v[36:43], v216
    buffer_load_dword v138, v217, s[24:27], 0 offen offset:0 sc1
    v_exp_f32 v21, v21
    v_smfmac_f32_32x32x32_bf16 v[68:83], v[112:115], v[44:51], v216
    buffer_load_dword v139, v217, s[24:27], 0 offen offset:128 sc1
    v_exp_f32 v22, v22
    v_exp_f32 v23, v23
    v_exp_f32 v24, v24
    v_smfmac_f32_16x16x64_bf16 v[88:91], v[212:215], v[44:51], v216
    v_exp_f32 v25, v25
    v_mfma_f32_32x32x16_bf16 v[36:51], v[100:103], v[12:15], 0
    v_exp_f32 v26, v26
    v_exp_f32 v27, v27
    v_exp_f32 v28, v28
    v_exp_f32 v29, v29
    v_mfma_f32_32x32x16_bf16 v[36:51], v[104:107], v[16:19], v[36:51]
    v_exp_f32 v30, v30
    v_exp_f32 v31, v31
    v_exp_f32 v32, v32
    v_exp_f32 v33, v33
    v_smfmac_f32_32x32x32_bf16 v[52:67], v[116:119], v[20:27], v216
    v_exp_f32 v34, v34
    v_exp_f32 v35, v35
    v_exp_f32 v36, v36
    v_smfmac_f32_16x16x64_bf16 v[84:87], v[212:215], v[20:27], v216
    v_exp_f32 v37, v37
    v_smfmac_f32_32x32x32_bf16 v[52:67], v[120:123], v[28:35], v216
    v_exp_f32 v38, v38
    v_exp_f32 v39, v39
    v_exp_f32 v40, v40
    v_smfmac_f32_16x16x64_bf16 v[84:87], v[212:215], v[28:35], v216
    v_exp_f32 v41, v41
    v_exp_f32 v42, v42
    v_exp_f32 v43, v43
    v_exp_f32 v44, v44
    v_exp_f32 v45, v45
    v_exp_f32 v46, v46
    v_exp_f32 v47, v47
    v_exp_f32 v48, v48
    v_exp_f32 v49, v49
    v_smfmac_f32_32x32x32_bf16 v[68:83], v[116:119], v[36:43], v216
    v_exp_f32 v50, v50
    v_exp_f32 v51, v51
    v_smfmac_f32_16x16x64_bf16 v[88:91], v[212:215], v[36:43], v216
    s_nop 0
    v_smfmac_f32_32x32x32_bf16 v[68:83], v[120:123], v[44:51], v216
    v_smfmac_f32_16x16x64_bf16 v[88:91], v[212:215], v[44:51], v216
    s_cmp_ge_u32 s6, 2
    s_cbranch_scc1 F_tail1
F_tail0:
    s_barrier
    s_add_u32 s65, s59, s7
    s_add_u32 s64, s62, 131072
    s_add_u32 m0, s65, 0
    s_nop 0
    buffer_load_dwordx4 v219, s[28:31], s62 offen lds
    s_nop 3
    v_mov_b32 v85, v84
    v_mov_b32 v89, v88
    s_nop 0
    v_permlane32_swap_b32 v84, v85
    s_add_u32 m0, s65, 1024
    s_nop 0
    buffer_load_dwordx4 v220, s[28:31], s62 offen lds
    v_permlane32_swap_b32 v88, v89
    v_add_f32 v3, v84, v88
    v_min_f32 v2, v84, v88
    v_fmac_f32 v3, 0, v52
    v_fmac_f32 v3, 0, v53
    s_add_u32 m0, s65, 2048
    s_nop 0
    buffer_load_dwordx4 v221, s[28:31], s62 offen lds
    v_fmac_f32 v3, 0, v54
    v_fmac_f32 v3, 0, v55
    v_fmac_f32 v3, 0, v56
    v_fmac_f32 v3, 0, v57
    v_fmac_f32 v3, 0, v58
    s_add_u32 m0, s65, 3072
    s_nop 0
    buffer_load_dwordx4 v222, s[28:31], s62 offen lds
    v_fmac_f32 v3, 0, v59
    v_fmac_f32 v3, 0, v60
    v_fmac_f32 v3, 0, v61
    v_fmac_f32 v3, 0, v62
    v_fmac_f32 v3, 0, v63
    s_add_u32 m0, s65, 4096
    s_nop 0
    buffer_load_dwordx4 v219, s[28:31], s64 offen lds
    v_fmac_f32 v3, 0, v64
    v_fmac_f32 v3, 0, v65
    v_fmac_f32 v3, 0, v66
    v_fmac_f32 v3, 0, v67
    v_fmac_f32 v3, 0, v68
    s_add_u32 m0, s65, 5120
    s_nop 0
    buffer_load_dwordx4 v220, s[28:31], s64 offen lds
    v_fmac_f32 v3, 0, v69
    v_fmac_f32 v3, 0, v70
    v_fmac_f32 v3, 0, v71
    v_fmac_f32 v3, 0, v72
    v_fmac_f32 v3, 0, v73
    s_add_u32 m0, s65, 6144
    s_nop 0
    buffer_load_dwordx4 v221, s[28:31], s64 offen lds
    v_fmac_f32 v3, 0, v74
    v_fmac_f32 v3, 0, v75
    v_fmac_f32 v3, 0, v76
    v_fmac_f32 v3, 0, v77
    v_fmac_f32 v3, 0, v78
    s_add_u32 m0, s65, 7168
    s_nop 0
    buffer_load_dwordx4 v222, s[28:31], s64 offen lds
    v_fmac_f32 v3, 0, v79
    v_fmac_f32 v3, 0, v80
    v_fmac_f32 v3, 0, v81
    v_fmac_f32 v3, 0, v82
    v_fmac_f32 v3, 0, v83
    s_add_u32 s62, s62, 128
    s_add_u32 s59, s59, 30720
    s_cmp_eq_u32 s59, 122880
    s_cselect_b32 s59, 0, s59
    v_cmp_nle_f32 vcc, 0x2b800000, v2
    s_nop 0
    s_mov_b64 s[64:65], vcc
    v_cmp_nge_f32 vcc, 0x5d800000, v3
    s_nop 0
    s_or_b64 s[64:65], s[64:65], vcc
    s_cbranch_scc1 F_slow
F_fin0:
    v_rcp_f32 v84, v84
    v_rcp_f32 v88, v88
    s_waitcnt vmcnt(8)
    s_barrier
    s_add_u32 s65, s59, s7
    s_add_u32 s64, s62, 131072
    s_add_u32 m0, s65, 0
    s_nop 0
    buffer_load_dwordx4 v219, s[28:31], s62 offen lds
    v_mul_f32 v84, v84, v138
    v_mul_f32 v88, v88, v139
    v_mul_f32 v52, v52, v84
    v_mul_f32 v53, v53, v84
    v_cvt_pk_bf16_f32 v20, v52, v53
    v_mul_f32 v54, v54, v84
    s_add_u32 m0, s65, 1024
    s_nop 0
    buffer_load_dwordx4 v220, s[28:31], s62 offen lds
    v_mul_f32 v55, v55, v84
    v_cvt_pk_bf16_f32 v21, v54, v55
    v_mul_f32 v56, v56, v84
    v_mul_f32 v57, v57, v84
    v_cvt_pk_bf16_f32 v22, v56, v57
    v_mul_f32 v58, v58, v84
    s_add_u32 m0, s65, 2048
    s_nop 0
    buffer_load_dwordx4 v221, s[28:31], s62 offen lds
    v_mul_f32 v59, v59, v84
    v_cvt_pk_bf16_f32 v23, v58, v59
    v_mul_f32 v60, v60, v84
    v_mul_f32 v61, v61, v84
    v_cvt_pk_bf16_f32 v24, v60, v61
    v_mul_f32 v62, v62, v84
    s_add_u32 m0, s65, 3072
    s_nop 0
    buffer_load_dwordx4 v222, s[28:31], s62 offen lds
    v_mul_f32 v63, v63, v84
    v_cvt_pk_bf16_f32 v25, v62, v63
    v_mul_f32 v64, v64, v84
    v_mul_f32 v65, v65, v84
    v_cvt_pk_bf16_f32 v26, v64, v65
    v_mul_f32 v66, v66, v84
    v_mul_f32 v67, v67, v84
    s_add_u32 m0, s65, 4096
    s_nop 0
    buffer_load_dwordx4 v219, s[28:31], s64 offen lds
    v_cvt_pk_bf16_f32 v27, v66, v67
    v_mul_f32 v68, v68, v88
    v_mul_f32 v69, v69, v88
    v_cvt_pk_bf16_f32 v28, v68, v69
    v_mul_f32 v70, v70, v88
    v_mul_f32 v71, v71, v88
    s_add_u32 m0, s65, 5120
    s_nop 0
    buffer_load_dwordx4 v220, s[28:31], s64 offen lds
    v_cvt_pk_bf16_f32 v29, v70, v71
    v_mul_f32 v72, v72, v88
    v_mul_f32 v73, v73, v88
    v_cvt_pk_bf16_f32 v30, v72, v73
    v_mul_f32 v74, v74, v88
    v_mul_f32 v75, v75, v88
    s_add_u32 m0, s65, 6144
    s_nop 0
    buffer_load_dwordx4 v221, s[28:31], s64 offen lds
    v_cvt_pk_bf16_f32 v31, v74, v75
    v_mul_f32 v76, v76, v88
    v_mul_f32 v77, v77, v88
    v_cvt_pk_bf16_f32 v32, v76, v77
    v_mul_f32 v78, v78, v88
    v_mul_f32 v79, v79, v88
    s_add_u32 m0, s65, 7168
    s_nop 0
    buffer_load_dwordx4 v222, s[28:31], s64 offen lds
    v_cvt_pk_bf16_f32 v33, v78, v79
    v_mul_f32 v80, v80, v88
    v_mul_f32 v81, v81, v88
    v_cvt_pk_bf16_f32 v34, v80, v81
    v_mul_f32 v82, v82, v88
    v_mul_f32 v83, v83, v88
    v_cvt_pk_bf16_f32 v35, v82, v83
    s_add_u32 s62, s62, 128
    s_add_u32 s59, s59, 30720
    s_cmp_eq_u32 s59, 122880
    s_cselect_b32 s59, 0, s59
    buffer_store_dwordx2 v[20:21], v224, s[24:27], s70 offen offset:0 sc1
    buffer_store_dwordx2 v[22:23], v224, s[24:27], s71 offen offset:0 sc1
    buffer_store_dwordx2 v[24:25], v224, s[24:27], s70 offen offset:2048 sc1
    buffer_store_dwordx2 v[26:27], v224, s[24:27], s71 offen offset:2048 sc1
    buffer_store_dwordx2 v[28:29], v225, s[24:27], s70 offen offset:0 sc1
    buffer_store_dwordx2 v[30:31], v225, s[24:27], s71 offen offset:0 sc1
    buffer_store_dwordx2 v[32:33], v225, s[24:27], s70 offen offset:2048 sc1
    buffer_store_dwordx2 v[34:35], v225, s[24:27], s71 offen offset:2048 sc1
    s_cmp_eq_u32 s6, 1
    s_cbranch_scc1 F_h31
F_h30:
    s_lshl_b32 s60, s78, 11
    s_add_u32 s60, s60, 4759552
    s_mov_b32 s58, 3
F_r00:
    s_waitcnt vmcnt(24)
    s_barrier
    s_add_u32 s65, s59, s7
    s_add_u32 s64, s62, 131072
    s_add_u32 m0, s65, 0
    s_nop 0
    buffer_load_dwordx4 v219, s[28:31], s62 offen lds
    s_add_u32 m0, s65, 1024
    s_nop 0
    buffer_load_dwordx4 v220, s[28:31], s62 offen lds
    s_add_u32 m0, s65, 2048
    s_nop 0
    buffer_load_dwordx4 v221, s[28:31], s62 offen lds
    s_add_u32 m0, s65, 3072
    s_nop 0
    buffer_load_dwordx4 v222, s[28:31], s62 offen lds
    s_add_u32 m0, s65, 4096
    s_nop 0
    buffer_load_dwordx4 v219, s[28:31], s64 offen lds
    s_add_u32 m0, s65, 5120
    s_nop 0
    buffer_load_dwordx4 v220, s[28:31], s64 offen lds
    s_add_u32 m0, s65, 6144
    s_nop 0
    buffer_load_dwordx4 v221, s[28:31], s64 offen lds
    s_add_u32 m0, s65, 7168
    s_nop 0
    buffer_load_dwordx4 v222, s[28:31], s64 offen lds
    s_add_u32 s62, s62, 128
    s_add_u32 s59, s59, 30720
    s_cmp_eq_u32 s59, 122880
    s_cselect_b32 s59, 0, s59
    s_sub_u32 s58, s58, 1
    s_cmp_lg_u32 s58, 0
    s_cbranch_scc1 F_r00
    s_mov_b32 s58, 1
F_r10:
    s_waitcnt vmcnt(16)
    s_barrier
    s_add_u32 s65, s59, s7
    s_add_u32 s64, s62, 131072
    s_add_u32 m0, s65, 0
    s_nop 0
    buffer_load_dwordx4 v219, s[28:31], s62 offen lds
    s_add_u32 m0, s65, 1024
    s_nop 0
    buffer_load_dwordx4 v220, s[28:31], s62 offen lds
    s_add_u32 m0, s65, 2048
    s_nop 0
    buffer_load_dwordx4 v221, s[28:31], s62 offen lds
    s_add_u32 m0, s65, 3072
    s_nop 0
    buffer_load_dwordx4 v222, s[28:31], s62 offen lds
    s_add_u32 m0, s65, 4096
    s_nop 0
    buffer_load_dwordx4 v219, s[28:31], s64 offen lds
    s_add_u32 m0, s65, 5120
    s_nop 0
    buffer_load_dwordx4 v220, s[28:31], s64 offen lds
    s_add_u32 m0, s65, 6144
    s_nop 0
    buffer_load_dwordx4 v221, s[28:31], s64 offen lds
    s_add_u32 m0, s65, 7168
    s_nop 0
    buffer_load_dwordx4 v222, s[28:31], s64 offen lds
    s_add_u32 s62, s62, 128
    s_add_u32 s59, s59, 30720
    s_cmp_eq_u32 s59, 122880
    s_cselect_b32 s59, 0, s59
    s_sub_u32 s58, s58, 1
    s_cmp_lg_u32 s58, 0
    s_cbranch_scc1 F_r10
    s_lshl_b32 s64, s3, 4
    s_add_u32 s64, s64, s4
    s_lshl_b32 s64, s64, 5
    s_and_b32 s65, s5, 3
    s_add_u32 s64, s64, s65
    s_lshl_b32 s64, s64, 2
    s_add_u32 s64, s64, 4759552
    s_waitcnt vmcnt(24)
    v_mov_b32 v6, 0
    buffer_store_dword v6, v6, s[24:27], s64 offen sc1
    v_lshrrev_b32 v145, 5, v0
    v_and_b32 v146, 4095, v223
    v_lshrrev_b32 v4, 3, v0
    v_lshlrev_b32 v4, 11, v4
    v_bfe_u32 v5, v0, 1, 2
    v_lshrrev_b32 v7, 4, v0
    v_xor_b32 v5, v5, v7
    v_lshl_add_u32 v4, v5, 5, v4
    v_and_b32 v5, 1, v0
    v_lshl_add_u32 v4, v5, 4, v4
    s_lshl_b32 s64, s79, 7
    v_add_u32 v144, s64, v4
    s_mov_b32 s58, 3
F_r20:
    s_waitcnt vmcnt(17)
    s_barrier
    s_add_u32 s65, s59, s7
    s_add_u32 s64, s62, 131072
    s_add_u32 m0, s65, 0
    s_nop 0
    buffer_load_dwordx4 v219, s[28:31], s62 offen lds
    s_add_u32 m0, s65, 1024
    s_nop 0
    buffer_load_dwordx4 v220, s[28:31], s62 offen lds
    s_add_u32 m0, s65, 2048
    s_nop 0
    buffer_load_dwordx4 v221, s[28:31], s62 offen lds
    s_add_u32 m0, s65, 3072
    s_nop 0
    buffer_load_dwordx4 v222, s[28:31], s62 offen lds
    s_add_u32 m0, s65, 4096
    s_nop 0
    buffer_load_dwordx4 v219, s[28:31], s64 offen lds
    s_add_u32 m0, s65, 5120
    s_nop 0
    buffer_load_dwordx4 v220, s[28:31], s64 offen lds
    s_add_u32 m0, s65, 6144
    s_nop 0
    buffer_load_dwordx4 v221, s[28:31], s64 offen lds
    s_add_u32 m0, s65, 7168
    s_nop 0
    buffer_load_dwordx4 v222, s[28:31], s64 offen lds
    s_add_u32 s62, s62, 128
    s_add_u32 s59, s59, 30720
    s_cmp_eq_u32 s59, 122880
    s_cselect_b32 s59, 0, s59
    s_sub_u32 s58, s58, 1
    s_cmp_lg_u32 s58, 0
    s_cbranch_scc1 F_r20
    s_mov_b32 s58, 19
F_ra0:
    s_waitcnt vmcnt(16)
    s_barrier
    s_add_u32 s65, s59, s7
    s_add_u32 s64, s62, 131072
    s_add_u32 m0, s65, 0
    s_nop 0
    buffer_load_dwordx4 v219, s[28:31], s62 offen lds
    s_add_u32 m0, s65, 1024
    s_nop 0
    buffer_load_dwordx4 v220, s[28:31], s62 offen lds
    s_add_u32 m0, s65, 2048
    s_nop 0
    buffer_load_dwordx4 v221, s[28:31], s62 offen lds
    s_add_u32 m0, s65, 3072
    s_nop 0
    buffer_load_dwordx4 v222, s[28:31], s62 offen lds
    s_add_u32 m0, s65, 4096
    s_nop 0
    buffer_load_dwordx4 v219, s[28:31], s64 offen lds
    s_add_u32 m0, s65, 5120
    s_nop 0
    buffer_load_dwordx4 v220, s[28:31], s64 offen lds
    s_add_u32 m0, s65, 6144
    s_nop 0
    buffer_load_dwordx4 v221, s[28:31], s64 offen lds
    s_add_u32 m0, s65, 7168
    s_nop 0
    buffer_load_dwordx4 v222, s[28:31], s64 offen lds
    s_add_u32 s62, s62, 128
    s_add_u32 s59, s59, 30720
    s_cmp_eq_u32 s59, 122880
    s_cselect_b32 s59, 0, s59
    s_sub_u32 s58, s58, 1
    s_cmp_lg_u32 s58, 0
    s_cbranch_scc1 F_ra0
    v_xor_b32 v5, 1024, v144
    s_bfe_u32 s61, s2, 0x10002
    s_mul_i32 s61, s61, 8
    s_add_u32 s61, s61, 0
    s_mov_b32 s59, 126976
    s_waitcnt vmcnt(16)
    s_barrier
    s_lshl_b32 s64, s61, 17
    s_add_u32 m0, s59, 0
    s_nop 0
    buffer_load_dwordx4 v144, s[40:43], s64 offen lds
    s_add_u32 m0, s59, 24576
    s_nop 0
    buffer_load_dwordx4 v5, s[40:43], s64 offen lds
    s_add_u32 s64, s64, 16384
    s_add_u32 m0, s59, 1024
    s_nop 0
    buffer_load_dwordx4 v144, s[40:43], s64 offen lds
    s_add_u32 m0, s59, 25600
    s_nop 0
    buffer_load_dwordx4 v5, s[40:43], s64 offen lds
    s_add_u32 s64, s64, 16384
    s_add_u32 m0, s59, 2048
    s_nop 0
    buffer_load_dwordx4 v144, s[40:43], s64 offen lds
    s_add_u32 m0, s59, 26624
    s_nop 0
    buffer_load_dwordx4 v5, s[40:43], s64 offen lds
    s_add_u32 s64, s64, 16384
    s_add_u32 m0, s59, 3072
    s_nop 0
    buffer_load_dwordx4 v144, s[40:43], s64 offen lds
    s_add_u32 m0, s59, 27648
    s_nop 0
    buffer_load_dwordx4 v5, s[40:43], s64 offen lds
    s_add_u32 s64, s64, 16384
    s_add_u32 m0, s59, 4096
    s_nop 0
    buffer_load_dwordx4 v144, s[40:43], s64 offen lds
    s_add_u32 m0, s59, 28672
    s_nop 0
    buffer_load_dwordx4 v5, s[40:43], s64 offen lds
    s_add_u32 s64, s64, 16384
    s_add_u32 m0, s59, 5120
    s_nop 0
    buffer_load_dwordx4 v144, s[40:43], s64 offen lds
    s_add_u32 m0, s59, 29696
    s_nop 0
    buffer_load_dwordx4 v5, s[40:43], s64 offen lds
    s_add_u32 s64, s64, 16384
    s_add_u32 m0, s59, 6144
    s_nop 0
    buffer_load_dwordx4 v144, s[40:43], s64 offen lds
    s_add_u32 m0, s59, 30720
    s_nop 0
    buffer_load_dwordx4 v5, s[40:43], s64 offen lds
    s_add_u32 s64, s64, 16384
    s_add_u32 m0, s59, 7168
    s_nop 0
    buffer_load_dwordx4 v144, s[40:43], s64 offen lds
    s_add_u32 m0, s59, 31744
    s_nop 0
    buffer_load_dwordx4 v5, s[40:43], s64 offen lds
    s_add_u32 s64, s64, 16384
    s_add_u32 s61, s61, 1
    s_add_u32 s59, s59, 32768
    s_cmp_eq_u32 s59, 159744
    s_cselect_b32 s59, 0, s59
    s_cmp_eq_u32 s59, 98304
    s_cselect_b32 s59, 126976, s59
    s_waitcnt vmcnt(24)
    s_barrier
    s_lshl_b32 s64, s61, 17
    s_add_u32 m0, s59, 0
    s_nop 0
    buffer_load_dwordx4 v144, s[40:43], s64 offen lds
    s_add_u32 m0, s59, 24576
    s_nop 0
    buffer_load_dwordx4 v5, s[40:43], s64 offen lds
    s_add_u32 s64, s64, 16384
    s_add_u32 m0, s59, 1024
    s_nop 0
    buffer_load_dwordx4 v144, s[40:43], s64 offen lds
    s_add_u32 m0, s59, 25600
    s_nop 0
    buffer_load_dwordx4 v5, s[40:43], s64 offen lds
    s_add_u32 s64, s64, 16384
    s_add_u32 m0, s59, 2048
    s_nop 0
    buffer_load_dwordx4 v144, s[40:43], s64 offen lds
    s_add_u32 m0, s59, 26624
    s_nop 0
    buffer_load_dwordx4 v5, s[40:43], s64 offen lds
    s_add_u32 s64, s64, 16384
    s_add_u32 m0, s59, 3072
    s_nop 0
    buffer_load_dwordx4 v144, s[40:43], s64 offen lds
    s_add_u32 m0, s59, 27648
    s_nop 0
    buffer_load_dwordx4 v5, s[40:43], s64 offen lds
    s_add_u32 s64, s64, 16384
    s_add_u32 m0, s59, 4096
    s_nop 0
    buffer_load_dwordx4 v144, s[40:43], s64 offen lds
    s_add_u32 m0, s59, 28672
    s_nop 0
    buffer_load_dwordx4 v5, s[40:43], s64 offen lds
    s_add_u32 s64, s64, 16384
    s_add_u32 m0, s59, 5120
    s_nop 0
    buffer_load_dwordx4 v144, s[40:43], s64 offen lds
    s_add_u32 m0, s59, 29696
    s_nop 0
    buffer_load_dwordx4 v5, s[40:43], s64 offen lds
    s_add_u32 s64, s64, 16384
    s_add_u32 m0, s59, 6144
    s_nop 0
    buffer_load_dwordx4 v144, s[40:43], s64 offen lds
    s_add_u32 m0, s59, 30720
    s_nop 0
    buffer_load_dwordx4 v5, s[40:43], s64 offen lds
    s_add_u32 s64, s64, 16384
    s_add_u32 m0, s59, 7168
    s_nop 0
    buffer_load_dwordx4 v144, s[40:43], s64 offen lds
    s_add_u32 m0, s59, 31744
    s_nop 0
    buffer_load_dwordx4 v5, s[40:43], s64 offen lds
    s_add_u32 s64, s64, 16384
    s_add_u32 s61, s61, 1
    s_add_u32 s59, s59, 32768
    s_cmp_eq_u32 s59, 159744
    s_cselect_b32 s59, 0, s59
    s_cmp_eq_u32 s59, 98304
    s_cselect_b32 s59, 126976, s59
    s_mov_b32 s58, 6
F_rc0:
    s_waitcnt vmcnt(32)
    s_barrier
    s_lshl_b32 s64, s61, 17
    s_add_u32 m0, s59, 0
    s_nop 0
    buffer_load_dwordx4 v144, s[40:43], s64 offen lds
    s_add_u32 m0, s59, 24576
    s_nop 0
    buffer_load_dwordx4 v5, s[40:43], s64 offen lds
    s_add_u32 s64, s64, 16384
    s_add_u32 m0, s59, 1024
    s_nop 0
    buffer_load_dwordx4 v144, s[40:43], s64 offen lds
    s_add_u32 m0, s59, 25600
    s_nop 0
    buffer_load_dwordx4 v5, s[40:43], s64 offen lds
    s_add_u32 s64, s64, 16384
    s_add_u32 m0, s59, 2048
    s_nop 0
    buffer_load_dwordx4 v144, s[40:43], s64 offen lds
    s_add_u32 m0, s59, 26624
    s_nop 0
    buffer_load_dwordx4 v5, s[40:43], s64 offen lds
    s_add_u32 s64, s64, 16384
    s_add_u32 m0, s59, 3072
    s_nop 0
    buffer_load_dwordx4 v144, s[40:43], s64 offen lds
    s_add_u32 m0, s59, 27648
    s_nop 0
    buffer_load_dwordx4 v5, s[40:43], s64 offen lds
    s_add_u32 s64, s64, 16384
    s_add_u32 m0, s59, 4096
    s_nop 0
    buffer_load_dwordx4 v144, s[40:43], s64 offen lds
    s_add_u32 m0, s59, 28672
    s_nop 0
    buffer_load_dwordx4 v5, s[40:43], s64 offen lds
    s_add_u32 s64, s64, 16384
    s_add_u32 m0, s59, 5120
    s_nop 0
    buffer_load_dwordx4 v144, s[40:43], s64 offen lds
    s_add_u32 m0, s59, 29696
    s_nop 0
    buffer_load_dwordx4 v5, s[40:43], s64 offen lds
    s_add_u32 s64, s64, 16384
    s_add_u32 m0, s59, 6144
    s_nop 0
    buffer_load_dwordx4 v144, s[40:43], s64 offen lds
    s_add_u32 m0, s59, 30720
    s_nop 0
    buffer_load_dwordx4 v5, s[40:43], s64 offen lds
    s_add_u32 s64, s64, 16384
    s_add_u32 m0, s59, 7168
    s_nop 0
    buffer_load_dwordx4 v144, s[40:43], s64 offen lds
    s_add_u32 m0, s59, 31744
    s_nop 0
    buffer_load_dwordx4 v5, s[40:43], s64 offen lds
    s_add_u32 s64, s64, 16384
    s_add_u32 s61, s61, 1
    s_add_u32 s59, s59, 32768
    s_cmp_eq_u32 s59, 159744
    s_cselect_b32 s59, 0, s59
    s_cmp_eq_u32 s59, 98304
    s_cselect_b32 s59, 126976, s59
    s_sub_u32 s58, s58, 1
    s_cmp_lg_u32 s58, 0
    s_cbranch_scc1 F_rc0
    s_bfe_u32 s61, s2, 0x10002
    s_mul_i32 s61, s61, 12
    s_add_u32 s61, s61, 0
    s_mov_b32 s58, 12
F_rd0:
    s_waitcnt vmcnt(32)
    s_barrier
    s_lshl_b32 s64, s61, 17
    s_add_u32 m0, s59, 0
    s_nop 0
    buffer_load_dwordx4 v144, s[44:47], s64 offen lds
    s_add_u32 m0, s59, 24576
    s_nop 0
    buffer_load_dwordx4 v5, s[44:47], s64 offen lds
    s_add_u32 s64, s64, 16384
    s_add_u32 m0, s59, 1024
    s_nop 0
    buffer_load_dwordx4 v144, s[44:47], s64 offen lds
    s_add_u32 m0, s59, 25600
    s_nop 0
    buffer_load_dwordx4 v5, s[44:47], s64 offen lds
    s_add_u32 s64, s64, 16384
    s_add_u32 m0, s59, 2048
    s_nop 0
    buffer_load_dwordx4 v144, s[44:47], s64 offen lds
    s_add_u32 m0, s59, 26624
    s_nop 0
    buffer_load_dwordx4 v5, s[44:47], s64 offen lds
    s_add_u32 s64, s64, 16384
    s_add_u32 m0, s59, 3072
    s_nop 0
    buffer_load_dwordx4 v144, s[44:47], s64 offen lds
    s_add_u32 m0, s59, 27648
    s_nop 0
    buffer_load_dwordx4 v5, s[44:47], s64 offen lds
    s_add_u32 s64, s64, 16384
    s_add_u32 m0, s59, 4096
    s_nop 0
    buffer_load_dwordx4 v144, s[44:47], s64 offen lds
    s_add_u32 m0, s59, 28672
    s_nop 0
    buffer_load_dwordx4 v5, s[44:47], s64 offen lds
    s_add_u32 s64, s64, 16384
    s_add_u32 m0, s59, 5120
    s_nop 0
    buffer_load_dwordx4 v144, s[44:47], s64 offen lds
    s_add_u32 m0, s59, 29696
    s_nop 0
    buffer_load_dwordx4 v5, s[44:47], s64 offen lds
    s_add_u32 s64, s64, 16384
    s_add_u32 m0, s59, 6144
    s_nop 0
    buffer_load_dwordx4 v144, s[44:47], s64 offen lds
    s_add_u32 m0, s59, 30720
    s_nop 0
    buffer_load_dwordx4 v5, s[44:47], s64 offen lds
    s_add_u32 s64, s64, 16384
    s_add_u32 m0, s59, 7168
    s_nop 0
    buffer_load_dwordx4 v144, s[44:47], s64 offen lds
    s_add_u32 m0, s59, 31744
    s_nop 0
    buffer_load_dwordx4 v5, s[44:47], s64 offen lds
    s_add_u32 s64, s64, 16384
    s_add_u32 s61, s61, 1
    s_add_u32 s59, s59, 32768
    s_cmp_eq_u32 s59, 159744
    s_cselect_b32 s59, 0, s59
    s_cmp_eq_u32 s59, 98304
    s_cselect_b32 s59, 126976, s59
    s_sub_u32 s58, s58, 1
    s_cmp_lg_u32 s58, 0
    s_cbranch_scc1 F_rd0
    s_mov_b32 s61, 24
    s_waitcnt vmcnt(32)
    s_barrier
    s_lshl_b32 s64, s61, 17
    s_add_u32 m0, s59, 0
    s_nop 0
    buffer_load_dwordx4 v144, s[44:47], s64 offen lds
    s_add_u32 s64, s64, 16384
    s_add_u32 m0, s59, 1024
    s_nop 0
    buffer_load_dwordx4 v144, s[44:47], s64 offen lds
    s_add_u32 s64, s64, 16384
    s_add_u32 m0, s59, 2048
    s_nop 0
    buffer_load_dwordx4 v144, s[44:47], s64 offen lds
    s_add_u32 s64, s64, 16384
    s_add_u32 m0, s59, 3072
    s_nop 0
    buffer_load_dwordx4 v144, s[44:47], s64 offen lds
    s_add_u32 s64, s64, 16384
    s_add_u32 m0, s59, 4096
    s_nop 0
    buffer_load_dwordx4 v144, s[44:47], s64 offen lds
    s_add_u32 s64, s64, 16384
    s_add_u32 m0, s59, 5120
    s_nop 0
    buffer_load_dwordx4 v144, s[44:47], s64 offen lds
    s_add_u32 s64, s64, 16384
    s_add_u32 m0, s59, 6144
    s_nop 0
    buffer_load_dwordx4 v144, s[44:47], s64 offen lds
    s_add_u32 s64, s64, 16384
    s_add_u32 m0, s59, 7168
    s_nop 0
    buffer_load_dwordx4 v144, s[44:47], s64 offen lds
    s_add_u32 s64, s64, 16384
    s_add_u32 s61, s61, 1
    s_add_u32 s59, s59, 32768
    s_cmp_eq_u32 s59, 159744
    s_cselect_b32 s59, 0, s59
    s_cmp_eq_u32 s59, 98304
    s_cselect_b32 s59, 126976, s59
    s_waitcnt vmcnt(24)
    s_barrier
    s_lshl_b32 s64, s61, 17
    s_add_u32 m0, s59, 0
    s_nop 0
    buffer_load_dwordx4 v144, s[44:47], s64 offen lds
    s_add_u32 s64, s64, 16384
    s_add_u32 m0, s59, 1024
    s_nop 0
    buffer_load_dwordx4 v144, s[44:47], s64 offen lds
    s_add_u32 s64, s64, 16384
    s_add_u32 m0, s59, 2048
    s_nop 0
    buffer_load_dwordx4 v144, s[44:47], s64 offen lds
    s_add_u32 s64, s64, 16384
    s_add_u32 m0, s59, 3072
    s_nop 0
    buffer_load_dwordx4 v144, s[44:47], s64 offen lds
    s_add_u32 s64, s64, 16384
    s_add_u32 m0, s59, 4096
    s_nop 0
    buffer_load_dwordx4 v144, s[44:47], s64 offen lds
    s_add_u32 s64, s64, 16384
    s_add_u32 m0, s59, 5120
    s_nop 0
    buffer_load_dwordx4 v144, s[44:47], s64 offen lds
    s_add_u32 s64, s64, 16384
    s_add_u32 m0, s59, 6144
    s_nop 0
    buffer_load_dwordx4 v144, s[44:47], s64 offen lds
    s_add_u32 s64, s64, 16384
    s_add_u32 m0, s59, 7168
    s_nop 0
    buffer_load_dwordx4 v144, s[44:47], s64 offen lds
    s_add_u32 s64, s64, 16384
    s_add_u32 s61, s61, 1
    s_add_u32 s59, s59, 32768
    s_cmp_eq_u32 s59, 159744
    s_cselect_b32 s59, 0, s59
    s_cmp_eq_u32 s59, 98304
    s_cselect_b32 s59, 126976, s59
    s_mov_b32 s58, 2
F_re0:
    s_waitcnt vmcnt(16)
    s_barrier
    s_lshl_b32 s64, s61, 17
    s_add_u32 m0, s59, 0
    s_nop 0
    buffer_load_dwordx4 v144, s[44:47], s64 offen lds
    s_add_u32 s64, s64, 16384
    s_add_u32 m0, s59, 1024
    s_nop 0
    buffer_load_dwordx4 v144, s[44:47], s64 offen lds
    s_add_u32 s64, s64, 16384
    s_add_u32 m0, s59, 2048
    s_nop 0
    buffer_load_dwordx4 v144, s[44:47], s64 offen lds
    s_add_u32 s64, s64, 16384
    s_add_u32 m0, s59, 3072
    s_nop 0
    buffer_load_dwordx4 v144, s[44:47], s64 offen lds
    s_add_u32 s64, s64, 16384
    s_add_u32 m0, s59, 4096
    s_nop 0
    buffer_load_dwordx4 v144, s[44:47], s64 offen lds
    s_add_u32 s64, s64, 16384
    s_add_u32 m0, s59, 5120
    s_nop 0
    buffer_load_dwordx4 v144, s[44:47], s64 offen lds
    s_add_u32 s64, s64, 16384
    s_add_u32 m0, s59, 6144
    s_nop 0
    buffer_load_dwordx4 v144, s[44:47], s64 offen lds
    s_add_u32 s64, s64, 16384
    s_add_u32 m0, s59, 7168
    s_nop 0
    buffer_load_dwordx4 v144, s[44:47], s64 offen lds
    s_add_u32 s64, s64, 16384
    s_add_u32 s61, s61, 1
    s_add_u32 s59, s59, 32768
    s_cmp_eq_u32 s59, 159744
    s_cselect_b32 s59, 0, s59
    s_cmp_eq_u32 s59, 98304
    s_cselect_b32 s59, 126976, s59
    s_sub_u32 s58, s58, 1
    s_cmp_lg_u32 s58, 0
    s_cbranch_scc1 F_re0
    s_waitcnt vmcnt(16)
    s_barrier
    s_waitcnt vmcnt(8)
    s_barrier
    s_waitcnt vmcnt(0)
    s_barrier
    s_waitcnt vmcnt(0)
    s_barrier
    s_branch F_end
F_h31:
    s_lshl_b32 s60, s78, 11
    s_add_u32 s60, s60, 4759552
    s_mov_b32 s58, 3
F_r01:
    s_waitcnt vmcnt(24)
    s_barrier
    s_add_u32 s65, s59, s7
    s_add_u32 s64, s62, 131072
    s_add_u32 m0, s65, 0
    s_nop 0
    buffer_load_dwordx4 v219, s[28:31], s62 offen lds
    s_add_u32 m0, s65, 1024
    s_nop 0
    buffer_load_dwordx4 v220, s[28:31], s62 offen lds
    s_add_u32 m0, s65, 2048
    s_nop 0
    buffer_load_dwordx4 v221, s[28:31], s62 offen lds
    s_add_u32 m0, s65, 3072
    s_nop 0
    buffer_load_dwordx4 v222, s[28:31], s62 offen lds
    s_add_u32 m0, s65, 4096
    s_nop 0
    buffer_load_dwordx4 v219, s[28:31], s64 offen lds
    s_add_u32 m0, s65, 5120
    s_nop 0
    buffer_load_dwordx4 v220, s[28:31], s64 offen lds
    s_add_u32 m0, s65, 6144
    s_nop 0
    buffer_load_dwordx4 v221, s[28:31], s64 offen lds
    s_add_u32 m0, s65, 7168
    s_nop 0
    buffer_load_dwordx4 v222, s[28:31], s64 offen lds
    s_add_u32 s62, s62, 128
    s_add_u32 s59, s59, 30720
    s_cmp_eq_u32 s59, 122880
    s_cselect_b32 s59, 0, s59
    s_sub_u32 s58, s58, 1
    s_cmp_lg_u32 s58, 0
    s_cbranch_scc1 F_r01
    s_mov_b32 s58, 1
F_r11:
    s_waitcnt vmcnt(16)
    s_barrier
    s_add_u32 s65, s59, s7
    s_add_u32 s64, s62, 131072
    s_add_u32 m0, s65, 0
    s_nop 0
    buffer_load_dwordx4 v219, s[28:31], s62 offen lds
    s_add_u32 m0, s65, 1024
    s_nop 0
    buffer_load_dwordx4 v220, s[28:31], s62 offen lds
    s_add_u32 m0, s65, 2048
    s_nop 0
    buffer_load_dwordx4 v221, s[28:31], s62 offen lds
    s_add_u32 m0, s65, 3072
    s_nop 0
    buffer_load_dwordx4 v222, s[28:31], s62 offen lds
    s_add_u32 m0, s65, 4096
    s_nop 0
    buffer_load_dwordx4 v219, s[28:31], s64 offen lds
    s_add_u32 m0, s65, 5120
    s_nop 0
    buffer_load_dwordx4 v220, s[28:31], s64 offen lds
    s_add_u32 m0, s65, 6144
    s_nop 0
    buffer_load_dwordx4 v221, s[28:31], s64 offen lds
    s_add_u32 m0, s65, 7168
    s_nop 0
    buffer_load_dwordx4 v222, s[28:31], s64 offen lds
    s_add_u32 s62, s62, 128
    s_add_u32 s59, s59, 30720
    s_cmp_eq_u32 s59, 122880
    s_cselect_b32 s59, 0, s59
    s_sub_u32 s58, s58, 1
    s_cmp_lg_u32 s58, 0
    s_cbranch_scc1 F_r11
    s_lshl_b32 s64, s3, 4
    s_add_u32 s64, s64, s4
    s_lshl_b32 s64, s64, 5
    s_and_b32 s65, s5, 3
    s_add_u32 s64, s64, s65
    s_lshl_b32 s64, s64, 2
    s_add_u32 s64, s64, 4759552
    s_waitcnt vmcnt(24)
    v_mov_b32 v6, 0
    buffer_store_dword v6, v6, s[24:27], s64 offen sc1
    v_lshrrev_b32 v145, 5, v0
    v_and_b32 v146, 4095, v223
    s_mov_b32 s58, 3
F_r21:
    s_waitcnt vmcnt(17)
    s_barrier
    s_add_u32 s65, s59, s7
    s_add_u32 s64, s62, 131072
    s_add_u32 m0, s65, 0
    s_nop 0
    buffer_load_dwordx4 v219, s[28:31], s62 offen lds
    s_add_u32 m0, s65, 1024
    s_nop 0
    buffer_load_dwordx4 v220, s[28:31], s62 offen lds
    s_add_u32 m0, s65, 2048
    s_nop 0
    buffer_load_dwordx4 v221, s[28:31], s62 offen lds
    s_add_u32 m0, s65, 3072
    s_nop 0
    buffer_load_dwordx4 v222, s[28:31], s62 offen lds
    s_add_u32 m0, s65, 4096
    s_nop 0
    buffer_load_dwordx4 v219, s[28:31], s64 offen lds
    s_add_u32 m0, s65, 5120
    s_nop 0
    buffer_load_dwordx4 v220, s[28:31], s64 offen lds
    s_add_u32 m0, s65, 6144
    s_nop 0
    buffer_load_dwordx4 v221, s[28:31], s64 offen lds
    s_add_u32 m0, s65, 7168
    s_nop 0
    buffer_load_dwordx4 v222, s[28:31], s64 offen lds
    s_add_u32 s62, s62, 128
    s_add_u32 s59, s59, 30720
    s_cmp_eq_u32 s59, 122880
    s_cselect_b32 s59, 0, s59
    s_sub_u32 s58, s58, 1
    s_cmp_lg_u32 s58, 0
    s_cbranch_scc1 F_r21
    s_mov_b32 s58, 15
F_ra1:
    s_waitcnt vmcnt(16)
    s_barrier
    s_add_u32 s65, s59, s7
    s_add_u32 s64, s62, 131072
    s_add_u32 m0, s65, 0
    s_nop 0
    buffer_load_dwordx4 v219, s[28:31], s62 offen lds
    s_add_u32 m0, s65, 1024
    s_nop 0
    buffer_load_dwordx4 v220, s[28:31], s62 offen lds
    s_add_u32 m0, s65, 2048
    s_nop 0
    buffer_load_dwordx4 v221, s[28:31], s62 offen lds
    s_add_u32 m0, s65, 3072
    s_nop 0
    buffer_load_dwordx4 v222, s[28:31], s62 offen lds
    s_add_u32 m0, s65, 4096
    s_nop 0
    buffer_load_dwordx4 v219, s[28:31], s64 offen lds
    s_add_u32 m0, s65, 5120
    s_nop 0
    buffer_load_dwordx4 v220, s[28:31], s64 offen lds
    s_add_u32 m0, s65, 6144
    s_nop 0
    buffer_load_dwordx4 v221, s[28:31], s64 offen lds
    s_add_u32 m0, s65, 7168
    s_nop 0
    buffer_load_dwordx4 v222, s[28:31], s64 offen lds
    s_add_u32 s62, s62, 128
    s_add_u32 s59, s59, 30720
    s_cmp_eq_u32 s59, 122880
    s_cselect_b32 s59, 0, s59
    s_sub_u32 s58, s58, 1
    s_cmp_lg_u32 s58, 0
    s_cbranch_scc1 F_ra1
    buffer_load_dword v4, v226, s[24:27], s60 offen sc1
    s_mov_b32 s58, 4
F_rb1:
    s_waitcnt vmcnt(16)
    s_barrier
    s_add_u32 s65, s59, s7
    s_add_u32 s64, s62, 131072
    s_add_u32 m0, s65, 0
    s_nop 0
    buffer_load_dwordx4 v219, s[28:31], s62 offen lds
    s_add_u32 m0, s65, 1024
    s_nop 0
    buffer_load_dwordx4 v220, s[28:31], s62 offen lds
    s_add_u32 m0, s65, 2048
    s_nop 0
    buffer_load_dwordx4 v221, s[28:31], s62 offen lds
    s_add_u32 m0, s65, 3072
    s_nop 0
    buffer_load_dwordx4 v222, s[28:31], s62 offen lds
    s_add_u32 m0, s65, 4096
    s_nop 0
    buffer_load_dwordx4 v219, s[28:31], s64 offen lds
    s_add_u32 m0, s65, 5120
    s_nop 0
    buffer_load_dwordx4 v220, s[28:31], s64 offen lds
    s_add_u32 m0, s65, 6144
    s_nop 0
    buffer_load_dwordx4 v221, s[28:31], s64 offen lds
    s_add_u32 m0, s65, 7168
    s_nop 0
    buffer_load_dwordx4 v222, s[28:31], s64 offen lds
    s_add_u32 s62, s62, 128
    s_add_u32 s59, s59, 30720
    s_cmp_eq_u32 s59, 122880
    s_cselect_b32 s59, 0, s59
    s_sub_u32 s58, s58, 1
    s_cmp_lg_u32 s58, 0
    s_cbranch_scc1 F_rb1
    v_cmp_eq_u32 vcc, -1, v4
    s_nop 4
    s_cbranch_vccz F_done1
    s_mov_b32 s69, 30000
F_poll1:
    buffer_load_dword v4, v226, s[24:27], s60 offen sc1
    s_waitcnt vmcnt(0)
    v_cmp_eq_u32 vcc, -1, v4
    s_nop 4
    s_cbranch_vccz F_done1
    s_sleep 2
    s_sub_u32 s69, s69, 1
    s_cmp_lg_u32 s69, 0
    s_cbranch_scc1 F_poll1
F_done1:
    s_mul_i32 s63, s78, 851968
    s_add_u32 s63, s63, 13631488
    s_bfe_u32 s61, s2, 0x10002
    s_mul_i32 s61, s61, 32
    s_add_u32 s61, s61, 0
    s_mov_b32 s59, 126976
    s_waitcnt vmcnt(16)
    s_barrier
    s_mul_i32 s64, s61, 9363
    s_lshr_b32 s64, s64, 16
    s_mul_i32 s65, s64, 7
    s_sub_u32 s65, s61, s65
    s_cmp_ge_u32 s65, 3
    s_addc_u32 s65, s65, 0
    s_lshl_b32 s64, s64, 5
    s_add_u32 s64, s64, s65
    s_lshl_b32 s64, s64, 7
    s_add_u32 s67, s61, 1
    s_mul_i32 s66, s67, 9363
    s_lshr_b32 s66, s66, 16
    s_mul_i32 s65, s66, 7
    s_sub_u32 s65, s67, s65
    s_cmp_ge_u32 s65, 3
    s_addc_u32 s65, s65, 0
    s_lshl_b32 s66, s66, 5
    s_add_u32 s66, s66, s65
    s_lshl_b32 s66, s66, 7
    s_sub_u32 s66, s66, s64
    v_mad_u32_u24 v147, v145, s66, v146
    s_add_u32 s64, s64, s63
    s_add_u32 m0, s59, 8192
    s_nop 0
    buffer_load_dwordx4 v147, s[24:27], s64 offen sc1 lds
    s_add_u32 s64, s64, 106496
    s_add_u32 m0, s59, 9216
    s_nop 0
    buffer_load_dwordx4 v147, s[24:27], s64 offen sc1 lds
    s_add_u32 s64, s64, 106496
    s_add_u32 m0, s59, 10240
    s_nop 0
    buffer_load_dwordx4 v147, s[24:27], s64 offen sc1 lds
    s_add_u32 s64, s64, 106496
    s_add_u32 m0, s59, 11264
    s_nop 0
    buffer_load_dwordx4 v147, s[24:27], s64 offen sc1 lds
    s_add_u32 s64, s64, 106496
    s_add_u32 m0, s59, 12288
    s_nop 0
    buffer_load_dwordx4 v147, s[24:27], s64 offen sc1 lds
    s_add_u32 s64, s64, 106496
    s_add_u32 m0, s59, 13312
    s_nop 0
    buffer_load_dwordx4 v147, s[24:27], s64 offen sc1 lds
    s_add_u32 s64, s64, 106496
    s_add_u32 m0, s59, 14336
    s_nop 0
    buffer_load_dwordx4 v147, s[24:27], s64 offen sc1 lds
    s_add_u32 s64, s64, 106496
    s_add_u32 m0, s59, 15360
    s_nop 0
    buffer_load_dwordx4 v147, s[24:27], s64 offen sc1 lds
    s_add_u32 s64, s64, 106496
    s_add_u32 s61, s61, 4
    s_add_u32 s59, s59, 32768
    s_cmp_eq_u32 s59, 159744
    s_cselect_b32 s59, 0, s59
    s_cmp_eq_u32 s59, 98304
    s_cselect_b32 s59, 126976, s59
    s_waitcnt vmcnt(16)
    s_barrier
    s_mul_i32 s64, s61, 9363
    s_lshr_b32 s64, s64, 16
    s_mul_i32 s65, s64, 7
    s_sub_u32 s65, s61, s65
    s_cmp_ge_u32 s65, 3
    s_addc_u32 s65, s65, 0
    s_lshl_b32 s64, s64, 5
    s_add_u32 s64, s64, s65
    s_lshl_b32 s64, s64, 7
    s_add_u32 s67, s61, 1
    s_mul_i32 s66, s67, 9363
    s_lshr_b32 s66, s66, 16
    s_mul_i32 s65, s66, 7
    s_sub_u32 s65, s67, s65
    s_cmp_ge_u32 s65, 3
    s_addc_u32 s65, s65, 0
    s_lshl_b32 s66, s66, 5
    s_add_u32 s66, s66, s65
    s_lshl_b32 s66, s66, 7
    s_sub_u32 s66, s66, s64
    v_mad_u32_u24 v147, v145, s66, v146
    s_add_u32 s64, s64, s63
    s_add_u32 m0, s59, 8192
    s_nop 0
    buffer_load_dwordx4 v147, s[24:27], s64 offen sc1 lds
    s_add_u32 s64, s64, 106496
    s_add_u32 m0, s59, 9216
    s_nop 0
    buffer_load_dwordx4 v147, s[24:27], s64 offen sc1 lds
    s_add_u32 s64, s64, 106496
    s_add_u32 m0, s59, 10240
    s_nop 0
    buffer_load_dwordx4 v147, s[24:27], s64 offen sc1 lds
    s_add_u32 s64, s64, 106496
    s_add_u32 m0, s59, 11264
    s_nop 0
    buffer_load_dwordx4 v147, s[24:27], s64 offen sc1 lds
    s_add_u32 s64, s64, 106496
    s_add_u32 m0, s59, 12288
    s_nop 0
    buffer_load_dwordx4 v147, s[24:27], s64 offen sc1 lds
    s_add_u32 s64, s64, 106496
    s_add_u32 m0, s59, 13312
    s_nop 0
    buffer_load_dwordx4 v147, s[24:27], s64 offen sc1 lds
    s_add_u32 s64, s64, 106496
    s_add_u32 m0, s59, 14336
    s_nop 0
    buffer_load_dwordx4 v147, s[24:27], s64 offen sc1 lds
    s_add_u32 s64, s64, 106496
    s_add_u32 m0, s59, 15360
    s_nop 0
    buffer_load_dwordx4 v147, s[24:27], s64 offen sc1 lds
    s_add_u32 s64, s64, 106496
    s_add_u32 s61, s61, 4
    s_add_u32 s59, s59, 32768
    s_cmp_eq_u32 s59, 159744
    s_cselect_b32 s59, 0, s59
    s_cmp_eq_u32 s59, 98304
    s_cselect_b32 s59, 126976, s59
    s_mov_b32 s58, 6
F_rc1:
    s_waitcnt vmcnt(16)
    s_barrier
    s_mul_i32 s64, s61, 9363
    s_lshr_b32 s64, s64, 16
    s_mul_i32 s65, s64, 7
    s_sub_u32 s65, s61, s65
    s_cmp_ge_u32 s65, 3
    s_addc_u32 s65, s65, 0
    s_lshl_b32 s64, s64, 5
    s_add_u32 s64, s64, s65
    s_lshl_b32 s64, s64, 7
    s_add_u32 s67, s61, 1
    s_mul_i32 s66, s67, 9363
    s_lshr_b32 s66, s66, 16
    s_mul_i32 s65, s66, 7
    s_sub_u32 s65, s67, s65
    s_cmp_ge_u32 s65, 3
    s_addc_u32 s65, s65, 0
    s_lshl_b32 s66, s66, 5
    s_add_u32 s66, s66, s65
    s_lshl_b32 s66, s66, 7
    s_sub_u32 s66, s66, s64
    v_mad_u32_u24 v147, v145, s66, v146
    s_add_u32 s64, s64, s63
    s_add_u32 m0, s59, 8192
    s_nop 0
    buffer_load_dwordx4 v147, s[24:27], s64 offen sc1 lds
    s_add_u32 s64, s64, 106496
    s_add_u32 m0, s59, 9216
    s_nop 0
    buffer_load_dwordx4 v147, s[24:27], s64 offen sc1 lds
    s_add_u32 s64, s64, 106496
    s_add_u32 m0, s59, 10240
    s_nop 0
    buffer_load_dwordx4 v147, s[24:27], s64 offen sc1 lds
    s_add_u32 s64, s64, 106496
    s_add_u32 m0, s59, 11264
    s_nop 0
    buffer_load_dwordx4 v147, s[24:27], s64 offen sc1 lds
    s_add_u32 s64, s64, 106496
    s_add_u32 m0, s59, 12288
    s_nop 0
    buffer_load_dwordx4 v147, s[24:27], s64 offen sc1 lds
    s_add_u32 s64, s64, 106496
    s_add_u32 m0, s59, 13312
    s_nop 0
    buffer_load_dwordx4 v147, s[24:27], s64 offen sc1 lds
    s_add_u32 s64, s64, 106496
    s_add_u32 m0, s59, 14336
    s_nop 0
    buffer_load_dwordx4 v147, s[24:27], s64 offen sc1 lds
    s_add_u32 s64, s64, 106496
    s_add_u32 m0, s59, 15360
    s_nop 0
    buffer_load_dwordx4 v147, s[24:27], s64 offen sc1 lds
    s_add_u32 s64, s64, 106496
    s_add_u32 s61, s61, 4
    s_add_u32 s59, s59, 32768
    s_cmp_eq_u32 s59, 159744
    s_cselect_b32 s59, 0, s59
    s_cmp_eq_u32 s59, 98304
    s_cselect_b32 s59, 126976, s59
    s_sub_u32 s58, s58, 1
    s_cmp_lg_u32 s58, 0
    s_cbranch_scc1 F_rc1
    s_bfe_u32 s61, s2, 0x10002
    s_mul_i32 s61, s61, 48
    s_add_u32 s61, s61, 70
    s_mov_b32 s58, 12
F_rd1:
    s_waitcnt vmcnt(16)
    s_barrier
    s_mul_i32 s64, s61, 9363
    s_lshr_b32 s64, s64, 16
    s_mul_i32 s65, s64, 7
    s_sub_u32 s65, s61, s65
    s_cmp_ge_u32 s65, 3
    s_addc_u32 s65, s65, 0
    s_lshl_b32 s64, s64, 5
    s_add_u32 s64, s64, s65
    s_lshl_b32 s64, s64, 7
    s_add_u32 s67, s61, 1
    s_mul_i32 s66, s67, 9363
    s_lshr_b32 s66, s66, 16
    s_mul_i32 s65, s66, 7
    s_sub_u32 s65, s67, s65
    s_cmp_ge_u32 s65, 3
    s_addc_u32 s65, s65, 0
    s_lshl_b32 s66, s66, 5
    s_add_u32 s66, s66, s65
    s_lshl_b32 s66, s66, 7
    s_sub_u32 s66, s66, s64
    v_mad_u32_u24 v147, v145, s66, v146
    s_add_u32 s64, s64, s63
    s_add_u32 m0, s59, 8192
    s_nop 0
    buffer_load_dwordx4 v147, s[24:27], s64 offen sc1 lds
    s_add_u32 s64, s64, 106496
    s_add_u32 m0, s59, 9216
    s_nop 0
    buffer_load_dwordx4 v147, s[24:27], s64 offen sc1 lds
    s_add_u32 s64, s64, 106496
    s_add_u32 m0, s59, 10240
    s_nop 0
    buffer_load_dwordx4 v147, s[24:27], s64 offen sc1 lds
    s_add_u32 s64, s64, 106496
    s_add_u32 m0, s59, 11264
    s_nop 0
    buffer_load_dwordx4 v147, s[24:27], s64 offen sc1 lds
    s_add_u32 s64, s64, 106496
    s_add_u32 m0, s59, 12288
    s_nop 0
    buffer_load_dwordx4 v147, s[24:27], s64 offen sc1 lds
    s_add_u32 s64, s64, 106496
    s_add_u32 m0, s59, 13312
    s_nop 0
    buffer_load_dwordx4 v147, s[24:27], s64 offen sc1 lds
    s_add_u32 s64, s64, 106496
    s_add_u32 m0, s59, 14336
    s_nop 0
    buffer_load_dwordx4 v147, s[24:27], s64 offen sc1 lds
    s_add_u32 s64, s64, 106496
    s_add_u32 m0, s59, 15360
    s_nop 0
    buffer_load_dwordx4 v147, s[24:27], s64 offen sc1 lds
    s_add_u32 s64, s64, 106496
    s_add_u32 s61, s61, 4
    s_add_u32 s59, s59, 32768
    s_cmp_eq_u32 s59, 159744
    s_cselect_b32 s59, 0, s59
    s_cmp_eq_u32 s59, 98304
    s_cselect_b32 s59, 126976, s59
    s_sub_u32 s58, s58, 1
    s_cmp_lg_u32 s58, 0
    s_cbranch_scc1 F_rd1
    s_mov_b32 s61, 166
    s_mov_b32 s58, 4
F_re1:
    s_waitcnt vmcnt(16)
    s_barrier
    s_mul_i32 s64, s61, 9363
    s_lshr_b32 s64, s64, 16
    s_mul_i32 s65, s64, 7
    s_sub_u32 s65, s61, s65
    s_cmp_ge_u32 s65, 3
    s_addc_u32 s65, s65, 0
    s_lshl_b32 s64, s64, 5
    s_add_u32 s64, s64, s65
    s_lshl_b32 s64, s64, 7
    s_add_u32 s67, s61, 1
    s_mul_i32 s66, s67, 9363
    s_lshr_b32 s66, s66, 16
    s_mul_i32 s65, s66, 7
    s_sub_u32 s65, s67, s65
    s_cmp_ge_u32 s65, 3
    s_addc_u32 s65, s65, 0
    s_lshl_b32 s66, s66, 5
    s_add_u32 s66, s66, s65
    s_lshl_b32 s66, s66, 7
    s_sub_u32 s66, s66, s64
    v_mad_u32_u24 v147, v145, s66, v146
    s_add_u32 s64, s64, s63
    s_add_u32 m0, s59, 8192
    s_nop 0
    buffer_load_dwordx4 v147, s[24:27], s64 offen sc1 lds
    s_add_u32 s64, s64, 106496
    s_add_u32 m0, s59, 9216
    s_nop 0
    buffer_load_dwordx4 v147, s[24:27], s64 offen sc1 lds
    s_add_u32 s64, s64, 106496
    s_add_u32 m0, s59, 10240
    s_nop 0
    buffer_load_dwordx4 v147, s[24:27], s64 offen sc1 lds
    s_add_u32 s64, s64, 106496
    s_add_u32 m0, s59, 11264
    s_nop 0
    buffer_load_dwordx4 v147, s[24:27], s64 offen sc1 lds
    s_add_u32 s64, s64, 106496
    s_add_u32 m0, s59, 12288
    s_nop 0
    buffer_load_dwordx4 v147, s[24:27], s64 offen sc1 lds
    s_add_u32 s64, s64, 106496
    s_add_u32 m0, s59, 13312
    s_nop 0
    buffer_load_dwordx4 v147, s[24:27], s64 offen sc1 lds
    s_add_u32 s64, s64, 106496
    s_add_u32 m0, s59, 14336
    s_nop 0
    buffer_load_dwordx4 v147, s[24:27], s64 offen sc1 lds
    s_add_u32 s64, s64, 106496
    s_add_u32 m0, s59, 15360
    s_nop 0
    buffer_load_dwordx4 v147, s[24:27], s64 offen sc1 lds
    s_add_u32 s64, s64, 106496
    s_add_u32 s61, s61, 4
    s_add_u32 s59, s59, 32768
    s_cmp_eq_u32 s59, 159744
    s_cselect_b32 s59, 0, s59
    s_cmp_eq_u32 s59, 98304
    s_cselect_b32 s59, 126976, s59
    s_sub_u32 s58, s58, 1
    s_cmp_lg_u32 s58, 0
    s_cbranch_scc1 F_re1
    s_waitcnt vmcnt(16)
    s_barrier
    s_waitcnt vmcnt(8)
    s_barrier
    s_waitcnt vmcnt(0)
    s_barrier
    s_waitcnt vmcnt(0)
    s_barrier
    s_branch F_end
F_tail1:
    s_barrier
    s_add_u32 s65, s59, s7
    s_add_u32 m0, s65, 0
    s_nop 0
    buffer_load_dwordx4 v223, s[24:27], s62 offen offset:0 sc1 lds
    s_nop 3
    v_mov_b32 v85, v84
    v_mov_b32 v89, v88
    s_nop 0
    v_permlane32_swap_b32 v84, v85
    v_permlane32_swap_b32 v88, v89
    s_add_u32 m0, s65, 896
    s_nop 0
    buffer_load_dwordx4 v223, s[24:27], s62 offen offset:128 sc1 lds
    v_add_f32 v3, v84, v88
    v_min_f32 v2, v84, v88
    v_fmac_f32 v3, 0, v52
    v_fmac_f32 v3, 0, v53
    v_fmac_f32 v3, 0, v54
    v_fmac_f32 v3, 0, v55
    s_add_u32 m0, s65, 1792
    s_nop 0
    buffer_load_dwordx4 v223, s[24:27], s62 offen offset:256 sc1 lds
    v_fmac_f32 v3, 0, v56
    v_fmac_f32 v3, 0, v57
    v_fmac_f32 v3, 0, v58
    v_fmac_f32 v3, 0, v59
    v_fmac_f32 v3, 0, v60
    s_add_u32 m0, s65, 2560
    s_nop 0
    buffer_load_dwordx4 v223, s[24:27], s62 offen offset:512 sc1 lds
    v_fmac_f32 v3, 0, v61
    v_fmac_f32 v3, 0, v62
    v_fmac_f32 v3, 0, v63
    v_fmac_f32 v3, 0, v64
    v_fmac_f32 v3, 0, v65
    v_fmac_f32 v3, 0, v66
    s_add_u32 m0, s65, 3456
    s_nop 0
    buffer_load_dwordx4 v223, s[24:27], s62 offen offset:640 sc1 lds
    v_fmac_f32 v3, 0, v67
    v_fmac_f32 v3, 0, v68
    v_fmac_f32 v3, 0, v69
    v_fmac_f32 v3, 0, v70
    v_fmac_f32 v3, 0, v71
    s_add_u32 m0, s65, 4352
    s_nop 0
    buffer_load_dwordx4 v223, s[24:27], s62 offen offset:768 sc1 lds
    v_fmac_f32 v3, 0, v72
    v_fmac_f32 v3, 0, v73
    v_fmac_f32 v3, 0, v74
    v_fmac_f32 v3, 0, v75
    v_fmac_f32 v3, 0, v76
    v_fmac_f32 v3, 0, v77
    s_add_u32 m0, s65, 5248
    s_nop 0
    buffer_load_dwordx4 v223, s[24:27], s62 offen offset:896 sc1 lds
    v_fmac_f32 v3, 0, v78
    v_fmac_f32 v3, 0, v79
    v_fmac_f32 v3, 0, v80
    v_fmac_f32 v3, 0, v81
    v_fmac_f32 v3, 0, v82
    v_fmac_f32 v3, 0, v83
    s_add_u32 s62, s62, 16384
    s_add_u32 s59, s59, 30720
    s_cmp_eq_u32 s59, 122880
    s_cselect_b32 s59, 0, s59
    v_cmp_nle_f32 vcc, 0x2b800000, v2
    s_nop 0
    s_mov_b64 s[64:65], vcc
    v_cmp_nge_f32 vcc, 0x5d800000, v3
    s_nop 0
    s_or_b64 s[64:65], s[64:65], vcc
    s_cbranch_scc1 F_slow
F_fin1:
    v_rcp_f32 v84, v84
    v_rcp_f32 v88, v88
    s_waitcnt vmcnt(7)
    s_barrier
    s_add_u32 s65, s59, s7
    s_add_u32 m0, s65, 0
    s_nop 0
    buffer_load_dwordx4 v223, s[24:27], s62 offen offset:0 sc1 lds
    v_mul_f32 v84, v84, v138
    v_mul_f32 v88, v88, v139
    v_mul_f32 v52, v52, v84
    v_mul_f32 v53, v53, v84
    v_cvt_pk_bf16_f32 v20, v52, v53
    v_mul_f32 v54, v54, v84
    v_mul_f32 v55, v55, v84
    s_add_u32 m0, s65, 896
    s_nop 0
    buffer_load_dwordx4 v223, s[24:27], s62 offen offset:128 sc1 lds
    v_cvt_pk_bf16_f32 v21, v54, v55
    v_mul_f32 v56, v56, v84
    v_mul_f32 v57, v57, v84
    v_cvt_pk_bf16_f32 v22, v56, v57
    v_mul_f32 v58, v58, v84
    v_mul_f32 v59, v59, v84
    v_cvt_pk_bf16_f32 v23, v58, v59
    s_add_u32 m0, s65, 1792
    s_nop 0
    buffer_load_dwordx4 v223, s[24:27], s62 offen offset:256 sc1 lds
    v_mul_f32 v60, v60, v84
    v_mul_f32 v61, v61, v84
    v_cvt_pk_bf16_f32 v24, v60, v61
    v_mul_f32 v62, v62, v84
    v_mul_f32 v63, v63, v84
    v_cvt_pk_bf16_f32 v25, v62, v63
    v_mul_f32 v64, v64, v84
    s_add_u32 m0, s65, 2560
    s_nop 0
    buffer_load_dwordx4 v223, s[24:27], s62 offen offset:512 sc1 lds
    v_mul_f32 v65, v65, v84
    v_cvt_pk_bf16_f32 v26, v64, v65
    v_mul_f32 v66, v66, v84
    v_mul_f32 v67, v67, v84
    v_cvt_pk_bf16_f32 v27, v66, v67
    v_mul_f32 v68, v68, v88
    v_mul_f32 v69, v69, v88
    s_add_u32 m0, s65, 3456
    s_nop 0
    buffer_load_dwordx4 v223, s[24:27], s62 offen offset:640 sc1 lds
    v_cvt_pk_bf16_f32 v28, v68, v69
    v_mul_f32 v70, v70, v88
    v_mul_f32 v71, v71, v88
    v_cvt_pk_bf16_f32 v29, v70, v71
    v_mul_f32 v72, v72, v88
    v_mul_f32 v73, v73, v88
    v_cvt_pk_bf16_f32 v30, v72, v73
    s_add_u32 m0, s65, 4352
    s_nop 0
    buffer_load_dwordx4 v223, s[24:27], s62 offen offset:768 sc1 lds
    v_mul_f32 v74, v74, v88
    v_mul_f32 v75, v75, v88
    v_cvt_pk_bf16_f32 v31, v74, v75
    v_mul_f32 v76, v76, v88
    v_mul_f32 v77, v77, v88
    v_cvt_pk_bf16_f32 v32, v76, v77
    v_mul_f32 v78, v78, v88
    s_add_u32 m0, s65, 5248
    s_nop 0
    buffer_load_dwordx4 v223, s[24:27], s62 offen offset:896 sc1 lds
    v_mul_f32 v79, v79, v88
    v_cvt_pk_bf16_f32 v33, v78, v79
    v_mul_f32 v80, v80, v88
    v_mul_f32 v81, v81, v88
    v_cvt_pk_bf16_f32 v34, v80, v81
    v_mul_f32 v82, v82, v88
    v_mul_f32 v83, v83, v88
    v_cvt_pk_bf16_f32 v35, v82, v83
    s_add_u32 s62, s62, 16384
    s_add_u32 s59, s59, 30720
    s_cmp_eq_u32 s59, 122880
    s_cselect_b32 s59, 0, s59
    buffer_store_dwordx2 v[20:21], v224, s[24:27], s70 offen offset:0 sc1
    buffer_store_dwordx2 v[22:23], v224, s[24:27], s71 offen offset:0 sc1
    buffer_store_dwordx2 v[24:25], v224, s[24:27], s70 offen offset:2048 sc1
    buffer_store_dwordx2 v[26:27], v224, s[24:27], s71 offen offset:2048 sc1
    buffer_store_dwordx2 v[28:29], v225, s[24:27], s70 offen offset:0 sc1
    buffer_store_dwordx2 v[30:31], v225, s[24:27], s71 offen offset:0 sc1
    buffer_store_dwordx2 v[32:33], v225, s[24:27], s70 offen offset:2048 sc1
    buffer_store_dwordx2 v[34:35], v225, s[24:27], s71 offen offset:2048 sc1
    s_cmp_eq_u32 s6, 3
    s_cbranch_scc1 F_h33
F_h32:
    s_lshl_b32 s60, s78, 11
    s_add_u32 s60, s60, 4759552
    s_mov_b32 s58, 3
F_r02:
    s_waitcnt vmcnt(22)
    s_barrier
    s_add_u32 s65, s59, s7
    s_add_u32 m0, s65, 0
    s_nop 0
    buffer_load_dwordx4 v223, s[24:27], s62 offen offset:0 sc1 lds
    s_add_u32 m0, s65, 896
    s_nop 0
    buffer_load_dwordx4 v223, s[24:27], s62 offen offset:128 sc1 lds
    s_add_u32 m0, s65, 1792
    s_nop 0
    buffer_load_dwordx4 v223, s[24:27], s62 offen offset:256 sc1 lds
    s_add_u32 m0, s65, 2560
    s_nop 0
    buffer_load_dwordx4 v223, s[24:27], s62 offen offset:512 sc1 lds
    s_add_u32 m0, s65, 3456
    s_nop 0
    buffer_load_dwordx4 v223, s[24:27], s62 offen offset:640 sc1 lds
    s_add_u32 m0, s65, 4352
    s_nop 0
    buffer_load_dwordx4 v223, s[24:27], s62 offen offset:768 sc1 lds
    s_add_u32 m0, s65, 5248
    s_nop 0
    buffer_load_dwordx4 v223, s[24:27], s62 offen offset:896 sc1 lds
    s_add_u32 s62, s62, 16384
    s_add_u32 s59, s59, 30720
    s_cmp_eq_u32 s59, 122880
    s_cselect_b32 s59, 0, s59
    s_sub_u32 s58, s58, 1
    s_cmp_lg_u32 s58, 0
    s_cbranch_scc1 F_r02
    s_mov_b32 s58, 1
F_r12:
    s_waitcnt vmcnt(14)
    s_barrier
    s_add_u32 s65, s59, s7
    s_add_u32 m0, s65, 0
    s_nop 0
    buffer_load_dwordx4 v223, s[24:27], s62 offen offset:0 sc1 lds
    s_add_u32 m0, s65, 896
    s_nop 0
    buffer_load_dwordx4 v223, s[24:27], s62 offen offset:128 sc1 lds
    s_add_u32 m0, s65, 1792
    s_nop 0
    buffer_load_dwordx4 v223, s[24:27], s62 offen offset:256 sc1 lds
    s_add_u32 m0, s65, 2560
    s_nop 0
    buffer_load_dwordx4 v223, s[24:27], s62 offen offset:512 sc1 lds
    s_add_u32 m0, s65, 3456
    s_nop 0
    buffer_load_dwordx4 v223, s[24:27], s62 offen offset:640 sc1 lds
    s_add_u32 m0, s65, 4352
    s_nop 0
    buffer_load_dwordx4 v223, s[24:27], s62 offen offset:768 sc1 lds
    s_add_u32 m0, s65, 5248
    s_nop 0
    buffer_load_dwordx4 v223, s[24:27], s62 offen offset:896 sc1 lds
    s_add_u32 s62, s62, 16384
    s_add_u32 s59, s59, 30720
    s_cmp_eq_u32 s59, 122880
    s_cselect_b32 s59, 0, s59
    s_sub_u32 s58, s58, 1
    s_cmp_lg_u32 s58, 0
    s_cbranch_scc1 F_r12
    s_lshl_b32 s64, s3, 4
    s_add_u32 s64, s64, s4
    s_lshl_b32 s64, s64, 5
    s_and_b32 s65, s5, 3
    s_add_u32 s64, s64, s65
    s_lshl_b32 s64, s64, 2
    s_add_u32 s64, s64, 4759552
    s_waitcnt vmcnt(21)
    v_mov_b32 v6, 0
    buffer_store_dword v6, v6, s[24:27], s64 offen sc1
    v_lshrrev_b32 v145, 5, v0
    v_and_b32 v146, 4095, v223
    s_mov_b32 s58, 3
F_r22:
    s_waitcnt vmcnt(15)
    s_barrier
    s_add_u32 s65, s59, s7
    s_add_u32 m0, s65, 0
    s_nop 0
    buffer_load_dwordx4 v223, s[24:27], s62 offen offset:0 sc1 lds
    s_add_u32 m0, s65, 896
    s_nop 0
    buffer_load_dwordx4 v223, s[24:27], s62 offen offset:128 sc1 lds
    s_add_u32 m0, s65, 1792
    s_nop 0
    buffer_load_dwordx4 v223, s[24:27], s62 offen offset:256 sc1 lds
    s_add_u32 m0, s65, 2560
    s_nop 0
    buffer_load_dwordx4 v223, s[24:27], s62 offen offset:512 sc1 lds
    s_add_u32 m0, s65, 3456
    s_nop 0
    buffer_load_dwordx4 v223, s[24:27], s62 offen offset:640 sc1 lds
    s_add_u32 m0, s65, 4352
    s_nop 0
    buffer_load_dwordx4 v223, s[24:27], s62 offen offset:768 sc1 lds
    s_add_u32 m0, s65, 5248
    s_nop 0
    buffer_load_dwordx4 v223, s[24:27], s62 offen offset:896 sc1 lds
    s_add_u32 s62, s62, 16384
    s_add_u32 s59, s59, 30720
    s_cmp_eq_u32 s59, 122880
    s_cselect_b32 s59, 0, s59
    s_sub_u32 s58, s58, 1
    s_cmp_lg_u32 s58, 0
    s_cbranch_scc1 F_r22
    s_mov_b32 s58, 15
F_ra2:
    s_waitcnt vmcnt(14)
    s_barrier
    s_add_u32 s65, s59, s7
    s_add_u32 m0, s65, 0
    s_nop 0
    buffer_load_dwordx4 v223, s[24:27], s62 offen offset:0 sc1 lds
    s_add_u32 m0, s65, 896
    s_nop 0
    buffer_load_dwordx4 v223, s[24:27], s62 offen offset:128 sc1 lds
    s_add_u32 m0, s65, 1792
    s_nop 0
    buffer_load_dwordx4 v223, s[24:27], s62 offen offset:256 sc1 lds
    s_add_u32 m0, s65, 2560
    s_nop 0
    buffer_load_dwordx4 v223, s[24:27], s62 offen offset:512 sc1 lds
    s_add_u32 m0, s65, 3456
    s_nop 0
    buffer_load_dwordx4 v223, s[24:27], s62 offen offset:640 sc1 lds
    s_add_u32 m0, s65, 4352
    s_nop 0
    buffer_load_dwordx4 v223, s[24:27], s62 offen offset:768 sc1 lds
    s_add_u32 m0, s65, 5248
    s_nop 0
    buffer_load_dwordx4 v223, s[24:27], s62 offen offset:896 sc1 lds
    s_add_u32 s62, s62, 16384
    s_add_u32 s59, s59, 30720
    s_cmp_eq_u32 s59, 122880
    s_cselect_b32 s59, 0, s59
    s_sub_u32 s58, s58, 1
    s_cmp_lg_u32 s58, 0
    s_cbranch_scc1 F_ra2
    buffer_load_dword v4, v226, s[24:27], s60 offen sc1
    s_getpc_b64 s[64:65]
F_pc2:
    s_sub_u32 s64, s64, F_pc2-gated_mix__grouped_kv_mqa__mixer_gmlp__prompt_kernel
    s_subb_u32 s65, s65, 0
    s_bfe_u32 s66, s2, 0x30003
    s_lshl_b32 s66, s66, 13
    v_lshl_add_u32 v5, v0, 7, s66
    v_min_u32 v5, F_exit-gated_mix__grouped_kv_mqa__mixer_gmlp__prompt_kernel, v5
    global_load_dword v5, v5, s[64:65]
    s_mov_b32 s58, 4
F_rb2:
    s_waitcnt vmcnt(14)
    s_barrier
    s_add_u32 s65, s59, s7
    s_add_u32 m0, s65, 0
    s_nop 0
    buffer_load_dwordx4 v223, s[24:27], s62 offen offset:0 sc1 lds
    s_add_u32 m0, s65, 896
    s_nop 0
    buffer_load_dwordx4 v223, s[24:27], s62 offen offset:128 sc1 lds
    s_add_u32 m0, s65, 1792
    s_nop 0
    buffer_load_dwordx4 v223, s[24:27], s62 offen offset:256 sc1 lds
    s_add_u32 m0, s65, 2560
    s_nop 0
    buffer_load_dwordx4 v223, s[24:27], s62 offen offset:512 sc1 lds
    s_add_u32 m0, s65, 3456
    s_nop 0
    buffer_load_dwordx4 v223, s[24:27], s62 offen offset:640 sc1 lds
    s_add_u32 m0, s65, 4352
    s_nop 0
    buffer_load_dwordx4 v223, s[24:27], s62 offen offset:768 sc1 lds
    s_add_u32 m0, s65, 5248
    s_nop 0
    buffer_load_dwordx4 v223, s[24:27], s62 offen offset:896 sc1 lds
    s_add_u32 s62, s62, 16384
    s_add_u32 s59, s59, 30720
    s_cmp_eq_u32 s59, 122880
    s_cselect_b32 s59, 0, s59
    s_sub_u32 s58, s58, 1
    s_cmp_lg_u32 s58, 0
    s_cbranch_scc1 F_rb2
    v_cmp_eq_u32 vcc, -1, v4
    s_nop 4
    s_cbranch_vccz F_done3
    s_mov_b32 s69, 30000
F_poll3:
    buffer_load_dword v4, v226, s[24:27], s60 offen sc1
    s_waitcnt vmcnt(0)
    v_cmp_eq_u32 vcc, -1, v4
    s_nop 4
    s_cbranch_vccz F_done3
    s_sleep 2
    s_sub_u32 s69, s69, 1
    s_cmp_lg_u32 s69, 0
    s_cbranch_scc1 F_poll3
F_done3:
    s_mul_i32 s63, s78, 851968
    s_add_u32 s63, s63, 13631488
    s_bfe_u32 s61, s2, 0x10002
    s_mul_i32 s61, s61, 32
    s_add_u32 s61, s61, 2
    s_mov_b32 s59, 126976
    s_waitcnt vmcnt(14)
    s_barrier
    s_mul_i32 s64, s61, 9363
    s_lshr_b32 s64, s64, 16
    s_mul_i32 s65, s64, 7
    s_sub_u32 s65, s61, s65
    s_cmp_ge_u32 s65, 3
    s_addc_u32 s65, s65, 0
    s_lshl_b32 s64, s64, 5
    s_add_u32 s64, s64, s65
    s_lshl_b32 s64, s64, 7
    s_add_u32 s67, s61, 1
    s_mul_i32 s66, s67, 9363
    s_lshr_b32 s66, s66, 16
    s_mul_i32 s65, s66, 7
    s_sub_u32 s65, s67, s65
    s_cmp_ge_u32 s65, 3
    s_addc_u32 s65, s65, 0
    s_lshl_b32 s66, s66, 5
    s_add_u32 s66, s66, s65
    s_lshl_b32 s66, s66, 7
    s_sub_u32 s66, s66, s64
    v_mad_u32_u24 v147, v145, s66, v146
    s_add_u32 s64, s64, s63
    s_add_u32 m0, s59, 16384
    s_nop 0
    buffer_load_dwordx4 v147, s[24:27], s64 offen sc1 lds
    s_add_u32 s64, s64, 106496
    s_add_u32 m0, s59, 17408
    s_nop 0
    buffer_load_dwordx4 v147, s[24:27], s64 offen sc1 lds
    s_add_u32 s64, s64, 106496
    s_add_u32 m0, s59, 18432
    s_nop 0
    buffer_load_dwordx4 v147, s[24:27], s64 offen sc1 lds
    s_add_u32 s64, s64, 106496
    s_add_u32 m0, s59, 19456
    s_nop 0
    buffer_load_dwordx4 v147, s[24:27], s64 offen sc1 lds
    s_add_u32 s64, s64, 106496
    s_add_u32 m0, s59, 20480
    s_nop 0
    buffer_load_dwordx4 v147, s[24:27], s64 offen sc1 lds
    s_add_u32 s64, s64, 106496
    s_add_u32 m0, s59, 21504
    s_nop 0
    buffer_load_dwordx4 v147, s[24:27], s64 offen sc1 lds
    s_add_u32 s64, s64, 106496
    s_add_u32 m0, s59, 22528
    s_nop 0
    buffer_load_dwordx4 v147, s[24:27], s64 offen sc1 lds
    s_add_u32 s64, s64, 106496
    s_add_u32 m0, s59, 23552
    s_nop 0
    buffer_load_dwordx4 v147, s[24:27], s64 offen sc1 lds
    s_add_u32 s64, s64, 106496
    s_add_u32 s61, s61, 4
    s_add_u32 s59, s59, 32768
    s_cmp_eq_u32 s59, 159744
    s_cselect_b32 s59, 0, s59
    s_cmp_eq_u32 s59, 98304
    s_cselect_b32 s59, 126976, s59
    s_waitcnt vmcnt(15)
    s_barrier
    s_mul_i32 s64, s61, 9363
    s_lshr_b32 s64, s64, 16
    s_mul_i32 s65, s64, 7
    s_sub_u32 s65, s61, s65
    s_cmp_ge_u32 s65, 3
    s_addc_u32 s65, s65, 0
    s_lshl_b32 s64, s64, 5
    s_add_u32 s64, s64, s65
    s_lshl_b32 s64, s64, 7
    s_add_u32 s67, s61, 1
    s_mul_i32 s66, s67, 9363
    s_lshr_b32 s66, s66, 16
    s_mul_i32 s65, s66, 7
    s_sub_u32 s65, s67, s65
    s_cmp_ge_u32 s65, 3
    s_addc_u32 s65, s65, 0
    s_lshl_b32 s66, s66, 5
    s_add_u32 s66, s66, s65
    s_lshl_b32 s66, s66, 7
    s_sub_u32 s66, s66, s64
    v_mad_u32_u24 v147, v145, s66, v146
    s_add_u32 s64, s64, s63
    s_add_u32 m0, s59, 16384
    s_nop 0
    buffer_load_dwordx4 v147, s[24:27], s64 offen sc1 lds
    s_add_u32 s64, s64, 106496
    s_add_u32 m0, s59, 17408
    s_nop 0
    buffer_load_dwordx4 v147, s[24:27], s64 offen sc1 lds
    s_add_u32 s64, s64, 106496
    s_add_u32 m0, s59, 18432
    s_nop 0
    buffer_load_dwordx4 v147, s[24:27], s64 offen sc1 lds
    s_add_u32 s64, s64, 106496
    s_add_u32 m0, s59, 19456
    s_nop 0
    buffer_load_dwordx4 v147, s[24:27], s64 offen sc1 lds
    s_add_u32 s64, s64, 106496
    s_add_u32 m0, s59, 20480
    s_nop 0
    buffer_load_dwordx4 v147, s[24:27], s64 offen sc1 lds
    s_add_u32 s64, s64, 106496
    s_add_u32 m0, s59, 21504
    s_nop 0
    buffer_load_dwordx4 v147, s[24:27], s64 offen sc1 lds
    s_add_u32 s64, s64, 106496
    s_add_u32 m0, s59, 22528
    s_nop 0
    buffer_load_dwordx4 v147, s[24:27], s64 offen sc1 lds
    s_add_u32 s64, s64, 106496
    s_add_u32 m0, s59, 23552
    s_nop 0
    buffer_load_dwordx4 v147, s[24:27], s64 offen sc1 lds
    s_add_u32 s64, s64, 106496
    s_add_u32 s61, s61, 4
    s_add_u32 s59, s59, 32768
    s_cmp_eq_u32 s59, 159744
    s_cselect_b32 s59, 0, s59
    s_cmp_eq_u32 s59, 98304
    s_cselect_b32 s59, 126976, s59
    s_mov_b32 s58, 6
F_rc2:
    s_waitcnt vmcnt(16)
    s_barrier
    s_mul_i32 s64, s61, 9363
    s_lshr_b32 s64, s64, 16
    s_mul_i32 s65, s64, 7
    s_sub_u32 s65, s61, s65
    s_cmp_ge_u32 s65, 3
    s_addc_u32 s65, s65, 0
    s_lshl_b32 s64, s64, 5
    s_add_u32 s64, s64, s65
    s_lshl_b32 s64, s64, 7
    s_add_u32 s67, s61, 1
    s_mul_i32 s66, s67, 9363
    s_lshr_b32 s66, s66, 16
    s_mul_i32 s65, s66, 7
    s_sub_u32 s65, s67, s65
    s_cmp_ge_u32 s65, 3
    s_addc_u32 s65, s65, 0
    s_lshl_b32 s66, s66, 5
    s_add_u32 s66, s66, s65
    s_lshl_b32 s66, s66, 7
    s_sub_u32 s66, s66, s64
    v_mad_u32_u24 v147, v145, s66, v146
    s_add_u32 s64, s64, s63
    s_add_u32 m0, s59, 16384
    s_nop 0
    buffer_load_dwordx4 v147, s[24:27], s64 offen sc1 lds
    s_add_u32 s64, s64, 106496
    s_add_u32 m0, s59, 17408
    s_nop 0
    buffer_load_dwordx4 v147, s[24:27], s64 offen sc1 lds
    s_add_u32 s64, s64, 106496
    s_add_u32 m0, s59, 18432
    s_nop 0
    buffer_load_dwordx4 v147, s[24:27], s64 offen sc1 lds
    s_add_u32 s64, s64, 106496
    s_add_u32 m0, s59, 19456
    s_nop 0
    buffer_load_dwordx4 v147, s[24:27], s64 offen sc1 lds
    s_add_u32 s64, s64, 106496
    s_add_u32 m0, s59, 20480
    s_nop 0
    buffer_load_dwordx4 v147, s[24:27], s64 offen sc1 lds
    s_add_u32 s64, s64, 106496
    s_add_u32 m0, s59, 21504
    s_nop 0
    buffer_load_dwordx4 v147, s[24:27], s64 offen sc1 lds
    s_add_u32 s64, s64, 106496
    s_add_u32 m0, s59, 22528
    s_nop 0
    buffer_load_dwordx4 v147, s[24:27], s64 offen sc1 lds
    s_add_u32 s64, s64, 106496
    s_add_u32 m0, s59, 23552
    s_nop 0
    buffer_load_dwordx4 v147, s[24:27], s64 offen sc1 lds
    s_add_u32 s64, s64, 106496
    s_add_u32 s61, s61, 4
    s_add_u32 s59, s59, 32768
    s_cmp_eq_u32 s59, 159744
    s_cselect_b32 s59, 0, s59
    s_cmp_eq_u32 s59, 98304
    s_cselect_b32 s59, 126976, s59
    s_sub_u32 s58, s58, 1
    s_cmp_lg_u32 s58, 0
    s_cbranch_scc1 F_rc2
    s_bfe_u32 s61, s2, 0x10002
    s_mul_i32 s61, s61, 48
    s_add_u32 s61, s61, 72
    s_mov_b32 s58, 12
F_rd2:
    s_waitcnt vmcnt(16)
    s_barrier
    s_mul_i32 s64, s61, 9363
    s_lshr_b32 s64, s64, 16
    s_mul_i32 s65, s64, 7
    s_sub_u32 s65, s61, s65
    s_cmp_ge_u32 s65, 3
    s_addc_u32 s65, s65, 0
    s_lshl_b32 s64, s64, 5
    s_add_u32 s64, s64, s65
    s_lshl_b32 s64, s64, 7
    s_add_u32 s67, s61, 1
    s_mul_i32 s66, s67, 9363
    s_lshr_b32 s66, s66, 16
    s_mul_i32 s65, s66, 7
    s_sub_u32 s65, s67, s65
    s_cmp_ge_u32 s65, 3
    s_addc_u32 s65, s65, 0
    s_lshl_b32 s66, s66, 5
    s_add_u32 s66, s66, s65
    s_lshl_b32 s66, s66, 7
    s_sub_u32 s66, s66, s64
    v_mad_u32_u24 v147, v145, s66, v146
    s_add_u32 s64, s64, s63
    s_add_u32 m0, s59, 16384
    s_nop 0
    buffer_load_dwordx4 v147, s[24:27], s64 offen sc1 lds
    s_add_u32 s64, s64, 106496
    s_add_u32 m0, s59, 17408
    s_nop 0
    buffer_load_dwordx4 v147, s[24:27], s64 offen sc1 lds
    s_add_u32 s64, s64, 106496
    s_add_u32 m0, s59, 18432
    s_nop 0
    buffer_load_dwordx4 v147, s[24:27], s64 offen sc1 lds
    s_add_u32 s64, s64, 106496
    s_add_u32 m0, s59, 19456
    s_nop 0
    buffer_load_dwordx4 v147, s[24:27], s64 offen sc1 lds
    s_add_u32 s64, s64, 106496
    s_add_u32 m0, s59, 20480
    s_nop 0
    buffer_load_dwordx4 v147, s[24:27], s64 offen sc1 lds
    s_add_u32 s64, s64, 106496
    s_add_u32 m0, s59, 21504
    s_nop 0
    buffer_load_dwordx4 v147, s[24:27], s64 offen sc1 lds
    s_add_u32 s64, s64, 106496
    s_add_u32 m0, s59, 22528
    s_nop 0
    buffer_load_dwordx4 v147, s[24:27], s64 offen sc1 lds
    s_add_u32 s64, s64, 106496
    s_add_u32 m0, s59, 23552
    s_nop 0
    buffer_load_dwordx4 v147, s[24:27], s64 offen sc1 lds
    s_add_u32 s64, s64, 106496
    s_add_u32 s61, s61, 4
    s_add_u32 s59, s59, 32768
    s_cmp_eq_u32 s59, 159744
    s_cselect_b32 s59, 0, s59
    s_cmp_eq_u32 s59, 98304
    s_cselect_b32 s59, 126976, s59
    s_sub_u32 s58, s58, 1
    s_cmp_lg_u32 s58, 0
    s_cbranch_scc1 F_rd2
    s_mov_b32 s61, 168
    s_mov_b32 s58, 4
F_re2:
    s_waitcnt vmcnt(16)
    s_barrier
    s_mul_i32 s64, s61, 9363
    s_lshr_b32 s64, s64, 16
    s_mul_i32 s65, s64, 7
    s_sub_u32 s65, s61, s65
    s_cmp_ge_u32 s65, 3
    s_addc_u32 s65, s65, 0
    s_lshl_b32 s64, s64, 5
    s_add_u32 s64, s64, s65
    s_lshl_b32 s64, s64, 7
    s_add_u32 s67, s61, 1
    s_mul_i32 s66, s67, 9363
    s_lshr_b32 s66, s66, 16
    s_mul_i32 s65, s66, 7
    s_sub_u32 s65, s67, s65
    s_cmp_ge_u32 s65, 3
    s_addc_u32 s65, s65, 0
    s_lshl_b32 s66, s66, 5
    s_add_u32 s66, s66, s65
    s_lshl_b32 s66, s66, 7
    s_sub_u32 s66, s66, s64
    v_mad_u32_u24 v147, v145, s66, v146
    s_add_u32 s64, s64, s63
    s_add_u32 m0, s59, 16384
    s_nop 0
    buffer_load_dwordx4 v147, s[24:27], s64 offen sc1 lds
    s_add_u32 s64, s64, 106496
    s_add_u32 m0, s59, 17408
    s_nop 0
    buffer_load_dwordx4 v147, s[24:27], s64 offen sc1 lds
    s_add_u32 s64, s64, 106496
    s_add_u32 m0, s59, 18432
    s_nop 0
    buffer_load_dwordx4 v147, s[24:27], s64 offen sc1 lds
    s_add_u32 s64, s64, 106496
    s_add_u32 m0, s59, 19456
    s_nop 0
    buffer_load_dwordx4 v147, s[24:27], s64 offen sc1 lds
    s_add_u32 s64, s64, 106496
    s_add_u32 m0, s59, 20480
    s_nop 0
    buffer_load_dwordx4 v147, s[24:27], s64 offen sc1 lds
    s_add_u32 s64, s64, 106496
    s_add_u32 m0, s59, 21504
    s_nop 0
    buffer_load_dwordx4 v147, s[24:27], s64 offen sc1 lds
    s_add_u32 s64, s64, 106496
    s_add_u32 m0, s59, 22528
    s_nop 0
    buffer_load_dwordx4 v147, s[24:27], s64 offen sc1 lds
    s_add_u32 s64, s64, 106496
    s_add_u32 m0, s59, 23552
    s_nop 0
    buffer_load_dwordx4 v147, s[24:27], s64 offen sc1 lds
    s_add_u32 s64, s64, 106496
    s_add_u32 s61, s61, 4
    s_add_u32 s59, s59, 32768
    s_cmp_eq_u32 s59, 159744
    s_cselect_b32 s59, 0, s59
    s_cmp_eq_u32 s59, 98304
    s_cselect_b32 s59, 126976, s59
    s_sub_u32 s58, s58, 1
    s_cmp_lg_u32 s58, 0
    s_cbranch_scc1 F_re2
    s_waitcnt vmcnt(16)
    s_barrier
    s_waitcnt vmcnt(8)
    s_barrier
    s_waitcnt vmcnt(0)
    s_barrier
    s_waitcnt vmcnt(0)
    s_barrier
    s_branch F_end
F_h33:
    s_lshl_b32 s60, s78, 11
    s_add_u32 s60, s60, 4792320
    s_mov_b32 s58, 3
F_r03:
    s_waitcnt vmcnt(22)
    s_barrier
    s_add_u32 s65, s59, s7
    s_add_u32 m0, s65, 0
    s_nop 0
    buffer_load_dwordx4 v223, s[24:27], s62 offen offset:0 sc1 lds
    s_add_u32 m0, s65, 896
    s_nop 0
    buffer_load_dwordx4 v223, s[24:27], s62 offen offset:128 sc1 lds
    s_add_u32 m0, s65, 1792
    s_nop 0
    buffer_load_dwordx4 v223, s[24:27], s62 offen offset:256 sc1 lds
    s_add_u32 m0, s65, 2560
    s_nop 0
    buffer_load_dwordx4 v223, s[24:27], s62 offen offset:512 sc1 lds
    s_add_u32 m0, s65, 3456
    s_nop 0
    buffer_load_dwordx4 v223, s[24:27], s62 offen offset:640 sc1 lds
    s_add_u32 m0, s65, 4352
    s_nop 0
    buffer_load_dwordx4 v223, s[24:27], s62 offen offset:768 sc1 lds
    s_add_u32 m0, s65, 5248
    s_nop 0
    buffer_load_dwordx4 v223, s[24:27], s62 offen offset:896 sc1 lds
    s_add_u32 s62, s62, 16384
    s_add_u32 s59, s59, 30720
    s_cmp_eq_u32 s59, 122880
    s_cselect_b32 s59, 0, s59
    s_sub_u32 s58, s58, 1
    s_cmp_lg_u32 s58, 0
    s_cbranch_scc1 F_r03
    s_mov_b32 s58, 1
F_r13:
    s_waitcnt vmcnt(14)
    s_barrier
    s_add_u32 s65, s59, s7
    s_add_u32 m0, s65, 0
    s_nop 0
    buffer_load_dwordx4 v223, s[24:27], s62 offen offset:0 sc1 lds
    s_add_u32 m0, s65, 896
    s_nop 0
    buffer_load_dwordx4 v223, s[24:27], s62 offen offset:128 sc1 lds
    s_add_u32 m0, s65, 1792
    s_nop 0
    buffer_load_dwordx4 v223, s[24:27], s62 offen offset:256 sc1 lds
    s_add_u32 m0, s65, 2560
    s_nop 0
    buffer_load_dwordx4 v223, s[24:27], s62 offen offset:512 sc1 lds
    s_add_u32 m0, s65, 3456
    s_nop 0
    buffer_load_dwordx4 v223, s[24:27], s62 offen offset:640 sc1 lds
    s_add_u32 m0, s65, 4352
    s_nop 0
    buffer_load_dwordx4 v223, s[24:27], s62 offen offset:768 sc1 lds
    s_add_u32 m0, s65, 5248
    s_nop 0
    buffer_load_dwordx4 v223, s[24:27], s62 offen offset:896 sc1 lds
    s_add_u32 s62, s62, 16384
    s_add_u32 s59, s59, 30720
    s_cmp_eq_u32 s59, 122880
    s_cselect_b32 s59, 0, s59
    s_sub_u32 s58, s58, 1
    s_cmp_lg_u32 s58, 0
    s_cbranch_scc1 F_r13
    s_lshl_b32 s64, s3, 4
    s_add_u32 s64, s64, s4
    s_lshl_b32 s64, s64, 5
    s_and_b32 s65, s5, 3
    s_add_u32 s64, s64, s65
    s_lshl_b32 s64, s64, 2
    s_add_u32 s64, s64, 4759552
    s_waitcnt vmcnt(21)
    v_mov_b32 v6, 0
    buffer_store_dword v6, v6, s[24:27], s64 offen sc1
    v_lshrrev_b32 v145, 5, v0
    v_and_b32 v146, 4095, v223
    s_mov_b32 s58, 3
F_r23:
    s_waitcnt vmcnt(15)
    s_barrier
    s_add_u32 s65, s59, s7
    s_add_u32 m0, s65, 0
    s_nop 0
    buffer_load_dwordx4 v223, s[24:27], s62 offen offset:0 sc1 lds
    s_add_u32 m0, s65, 896
    s_nop 0
    buffer_load_dwordx4 v223, s[24:27], s62 offen offset:128 sc1 lds
    s_add_u32 m0, s65, 1792
    s_nop 0
    buffer_load_dwordx4 v223, s[24:27], s62 offen offset:256 sc1 lds
    s_add_u32 m0, s65, 2560
    s_nop 0
    buffer_load_dwordx4 v223, s[24:27], s62 offen offset:512 sc1 lds
    s_add_u32 m0, s65, 3456
    s_nop 0
    buffer_load_dwordx4 v223, s[24:27], s62 offen offset:640 sc1 lds
    s_add_u32 m0, s65, 4352
    s_nop 0
    buffer_load_dwordx4 v223, s[24:27], s62 offen offset:768 sc1 lds
    s_add_u32 m0, s65, 5248
    s_nop 0
    buffer_load_dwordx4 v223, s[24:27], s62 offen offset:896 sc1 lds
    s_add_u32 s62, s62, 16384
    s_add_u32 s59, s59, 30720
    s_cmp_eq_u32 s59, 122880
    s_cselect_b32 s59, 0, s59
    s_sub_u32 s58, s58, 1
    s_cmp_lg_u32 s58, 0
    s_cbranch_scc1 F_r23
    s_mov_b32 s58, 15
F_ra3:
    s_waitcnt vmcnt(14)
    s_barrier
    s_add_u32 s65, s59, s7
    s_add_u32 m0, s65, 0
    s_nop 0
    buffer_load_dwordx4 v223, s[24:27], s62 offen offset:0 sc1 lds
    s_add_u32 m0, s65, 896
    s_nop 0
    buffer_load_dwordx4 v223, s[24:27], s62 offen offset:128 sc1 lds
    s_add_u32 m0, s65, 1792
    s_nop 0
    buffer_load_dwordx4 v223, s[24:27], s62 offen offset:256 sc1 lds
    s_add_u32 m0, s65, 2560
    s_nop 0
    buffer_load_dwordx4 v223, s[24:27], s62 offen offset:512 sc1 lds
    s_add_u32 m0, s65, 3456
    s_nop 0
    buffer_load_dwordx4 v223, s[24:27], s62 offen offset:640 sc1 lds
    s_add_u32 m0, s65, 4352
    s_nop 0
    buffer_load_dwordx4 v223, s[24:27], s62 offen offset:768 sc1 lds
    s_add_u32 m0, s65, 5248
    s_nop 0
    buffer_load_dwordx4 v223, s[24:27], s62 offen offset:896 sc1 lds
    s_add_u32 s62, s62, 16384
    s_add_u32 s59, s59, 30720
    s_cmp_eq_u32 s59, 122880
    s_cselect_b32 s59, 0, s59
    s_sub_u32 s58, s58, 1
    s_cmp_lg_u32 s58, 0
    s_cbranch_scc1 F_ra3
    v_and_b32 v5, 31, v0
    v_min_u32 v5, 15, v5
    s_lshr_b32 s64, s2, 3
    v_lshl_add_u32 v5, v5, 5, s64
    v_lshlrev_b32 v5, 11, v5
    v_lshl_add_u32 v5, v145, 10, v5
    s_bfe_u32 s64, s2, 0x10002
    s_mul_i32 s64, s64, 1048576
    buffer_load_dword v6, v5, s[40:43], s64 offen offset:384
    s_mov_b32 s58, 4
F_rb3:
    s_waitcnt vmcnt(14)
    s_barrier
    s_add_u32 s65, s59, s7
    s_add_u32 m0, s65, 0
    s_nop 0
    buffer_load_dwordx4 v223, s[24:27], s62 offen offset:0 sc1 lds
    s_add_u32 m0, s65, 896
    s_nop 0
    buffer_load_dwordx4 v223, s[24:27], s62 offen offset:128 sc1 lds
    s_add_u32 m0, s65, 1792
    s_nop 0
    buffer_load_dwordx4 v223, s[24:27], s62 offen offset:256 sc1 lds
    s_add_u32 m0, s65, 2560
    s_nop 0
    buffer_load_dwordx4 v223, s[24:27], s62 offen offset:512 sc1 lds
    s_add_u32 m0, s65, 3456
    s_nop 0
    buffer_load_dwordx4 v223, s[24:27], s62 offen offset:640 sc1 lds
    s_add_u32 m0, s65, 4352
    s_nop 0
    buffer_load_dwordx4 v223, s[24:27], s62 offen offset:768 sc1 lds
    s_add_u32 m0, s65, 5248
    s_nop 0
    buffer_load_dwordx4 v223, s[24:27], s62 offen offset:896 sc1 lds
    s_add_u32 s62, s62, 16384
    s_add_u32 s59, s59, 30720
    s_cmp_eq_u32 s59, 122880
    s_cselect_b32 s59, 0, s59
    s_sub_u32 s58, s58, 1
    s_cmp_lg_u32 s58, 0
    s_cbranch_scc1 F_rb3
    s_bfe_u32 s61, s2, 0x10002
    s_mul_i32 s61, s61, 32
    s_add_u32 s61, s61, 4
    s_mov_b32 s59, 126976
    s_waitcnt vmcnt(14)
    s_barrier
    s_waitcnt vmcnt(7)
    s_barrier
    s_waitcnt vmcnt(0)
    s_barrier
    s_barrier
    s_barrier
    s_barrier
    v_and_b32 v5, 31, v0
    v_min_u32 v5, 23, v5
    s_lshr_b32 s64, s2, 3
    v_lshl_add_u32 v5, v5, 5, s64
    v_lshlrev_b32 v5, 11, v5
    v_lshl_add_u32 v5, v145, 10, v5
    s_bfe_u32 s64, s2, 0x10002
    s_mul_i32 s64, s64, 1572864
    buffer_load_dword v6, v5, s[44:47], s64 offen offset:384
    s_lshr_b32 s64, s2, 3
    v_lshl_add_u32 v5, v0, 5, s64
    v_lshlrev_b32 v5, 11, v5
    s_and_b32 s64, s79, 8
    s_lshl_b32 s64, s64, 7
    s_add_u32 s64, s64, 3146112
    buffer_load_dword v6, v5, s[44:47], s64 offen
    s_barrier
    buffer_load_dword v4, v226, s[24:27], s60 offen sc1
    s_barrier
    s_waitcnt vmcnt(0)
    v_cmp_eq_u32 vcc, -1, v4
    s_nop 4
    s_cbranch_vccz F_done4
    s_mov_b32 s69, 30000
F_poll4:
    buffer_load_dword v4, v226, s[24:27], s60 offen sc1
    s_waitcnt vmcnt(0)
    v_cmp_eq_u32 vcc, -1, v4
    s_nop 4
    s_cbranch_vccz F_done4
    s_sleep 1
    s_sub_u32 s69, s69, 1
    s_cmp_lg_u32 s69, 0
    s_cbranch_scc1 F_poll4
F_done4:
    s_branch F_end
F_slow:
    v_mov_b32 v140, 0xff800000
    v_mov_b32 v142, 0xff800000
    s_mov_b32 s64, 4194304
F_slow1:
    buffer_load_dwordx4 v[92:95], v1, s[24:27], s64 offen offset:0 sc1
    buffer_load_dwordx4 v[96:99], v1, s[24:27], s64 offen offset:1024 sc1
    s_waitcnt vmcnt(0)
    v_mfma_f32_32x32x16_bf16 v[20:35], v[92:95], v[4:7], 0
    v_mfma_f32_32x32x16_bf16 v[20:35], v[96:99], v[8:11], v[20:35]
    v_mfma_f32_32x32x16_bf16 v[36:51], v[92:95], v[12:15], 0
    v_mfma_f32_32x32x16_bf16 v[36:51], v[96:99], v[16:19], v[36:51]
    s_nop 7
    v_max3_f32 v140, v20, v21, v140
    v_max3_f32 v140, v22, v23, v140
    v_max3_f32 v140, v24, v25, v140
    v_max3_f32 v140, v26, v27, v140
    v_max3_f32 v140, v28, v29, v140
    v_max3_f32 v140, v30, v31, v140
    v_max3_f32 v140, v32, v33, v140
    v_max3_f32 v140, v34, v35, v140
    v_max3_f32 v142, v36, v37, v142
    v_max3_f32 v142, v38, v39, v142
    v_max3_f32 v142, v40, v41, v142
    v_max3_f32 v142, v42, v43, v142
    v_max3_f32 v142, v44, v45, v142
    v_max3_f32 v142, v46, v47, v142
    v_max3_f32 v142, v48, v49, v142
    v_max3_f32 v142, v50, v51, v142
    s_add_u32 s64, s64, 4096
    s_cmp_lt_u32 s64, 4456448
    s_cbranch_scc1 F_slow1
    v_mov_b32 v141, v140
    s_nop 1
    v_permlane32_swap_b32 v140, v141
    v_max_f32 v140, v140, v141
    v_mov_b32 v143, v142
    s_nop 1
    v_permlane32_swap_b32 v142, v143
    v_max_f32 v142, v142, v143
    v_mov_b32 v52, 0
    v_mov_b32 v53, 0
    v_mov_b32 v54, 0
    v_mov_b32 v55, 0
    v_mov_b32 v56, 0
    v_mov_b32 v57, 0
    v_mov_b32 v58, 0
    v_mov_b32 v59, 0
    v_mov_b32 v60, 0
    v_mov_b32 v61, 0
    v_mov_b32 v62, 0
    v_mov_b32 v63, 0
    v_mov_b32 v64, 0
    v_mov_b32 v65, 0
    v_mov_b32 v66, 0
    v_mov_b32 v67, 0
    v_mov_b32 v68, 0
    v_mov_b32 v69, 0
    v_mov_b32 v70, 0
    v_mov_b32 v71, 0
    v_mov_b32 v72, 0
    v_mov_b32 v73, 0
    v_mov_b32 v74, 0
    v_mov_b32 v75, 0
    v_mov_b32 v76, 0
    v_mov_b32 v77, 0
    v_mov_b32 v78, 0
    v_mov_b32 v79, 0
    v_mov_b32 v80, 0
    v_mov_b32 v81, 0
    v_mov_b32 v82, 0
    v_mov_b32 v83, 0
    v_mov_b32 v84, 0
    v_mov_b32 v85, 0
    v_mov_b32 v86, 0
    v_mov_b32 v87, 0
    v_mov_b32 v88, 0
    v_mov_b32 v89, 0
    v_mov_b32 v90, 0
    v_mov_b32 v91, 0
    s_mov_b32 s64, 4194304
F_slow2:
    buffer_load_dwordx4 v[92:95], v1, s[24:27], s64 offen offset:0 sc1
    buffer_load_dwordx4 v[96:99], v1, s[24:27], s64 offen offset:1024 sc1
    buffer_load_dwordx4 v[108:111], v1, s[24:27], s64 offen offset:2048 sc1
    buffer_load_dwordx4 v[112:115], v1, s[24:27], s64 offen offset:3072 sc1
    s_waitcnt vmcnt(0)
    v_mfma_f32_32x32x16_bf16 v[20:35], v[92:95], v[4:7], 0
    v_mfma_f32_32x32x16_bf16 v[20:35], v[96:99], v[8:11], v[20:35]
    v_mfma_f32_32x32x16_bf16 v[36:51], v[92:95], v[12:15], 0
    v_mfma_f32_32x32x16_bf16 v[36:51], v[96:99], v[16:19], v[36:51]
    s_nop 7
    v_sub_f32 v20, v20, v140
    v_exp_f32 v20, v20
    v_sub_f32 v21, v21, v140
    v_exp_f32 v21, v21
    v_sub_f32 v22, v22, v140
    v_exp_f32 v22, v22
    v_sub_f32 v23, v23, v140
    v_exp_f32 v23, v23
    v_sub_f32 v24, v24, v140
    v_exp_f32 v24, v24
    v_sub_f32 v25, v25, v140
    v_exp_f32 v25, v25
    v_sub_f32 v26, v26, v140
    v_exp_f32 v26, v26
    v_sub_f32 v27, v27, v140
    v_exp_f32 v27, v27
    v_sub_f32 v28, v28, v140
    v_exp_f32 v28, v28
    v_sub_f32 v29, v29, v140
    v_exp_f32 v29, v29
    v_sub_f32 v30, v30, v140
    v_exp_f32 v30, v30
    v_sub_f32 v31, v31, v140
    v_exp_f32 v31, v31
    v_sub_f32 v32, v32, v140
    v_exp_f32 v32, v32
    v_sub_f32 v33, v33, v140
    v_exp_f32 v33, v33
    v_sub_f32 v34, v34, v140
    v_exp_f32 v34, v34
    v_sub_f32 v35, v35, v140
    v_exp_f32 v35, v35
    v_sub_f32 v36, v36, v142
    v_exp_f32 v36, v36
    v_sub_f32 v37, v37, v142
    v_exp_f32 v37, v37
    v_sub_f32 v38, v38, v142
    v_exp_f32 v38, v38
    v_sub_f32 v39, v39, v142
    v_exp_f32 v39, v39
    v_sub_f32 v40, v40, v142
    v_exp_f32 v40, v40
    v_sub_f32 v41, v41, v142
    v_exp_f32 v41, v41
    v_sub_f32 v42, v42, v142
    v_exp_f32 v42, v42
    v_sub_f32 v43, v43, v142
    v_exp_f32 v43, v43
    v_sub_f32 v44, v44, v142
    v_exp_f32 v44, v44
    v_sub_f32 v45, v45, v142
    v_exp_f32 v45, v45
    v_sub_f32 v46, v46, v142
    v_exp_f32 v46, v46
    v_sub_f32 v47, v47, v142
    v_exp_f32 v47, v47
    v_sub_f32 v48, v48, v142
    v_exp_f32 v48, v48
    v_sub_f32 v49, v49, v142
    v_exp_f32 v49, v49
    v_sub_f32 v50, v50, v142
    v_exp_f32 v50, v50
    v_sub_f32 v51, v51, v142
    v_exp_f32 v51, v51
    v_smfmac_f32_32x32x32_bf16 v[52:67], v[108:111], v[20:27], v216
    v_smfmac_f32_32x32x32_bf16 v[52:67], v[112:115], v[28:35], v216
    v_smfmac_f32_16x16x64_bf16 v[84:87], v[212:215], v[20:27], v216
    v_smfmac_f32_16x16x64_bf16 v[84:87], v[212:215], v[28:35], v216
    v_smfmac_f32_32x32x32_bf16 v[68:83], v[108:111], v[36:43], v216
    v_smfmac_f32_32x32x32_bf16 v[68:83], v[112:115], v[44:51], v216
    v_smfmac_f32_16x16x64_bf16 v[88:91], v[212:215], v[36:43], v216
    v_smfmac_f32_16x16x64_bf16 v[88:91], v[212:215], v[44:51], v216
    s_add_u32 s64, s64, 4096
    s_cmp_lt_u32 s64, 4456448
    s_cbranch_scc1 F_slow2
    s_nop 15
    v_mov_b32 v85, v84
    v_mov_b32 v89, v88
    s_nop 0
    v_permlane32_swap_b32 v84, v85
    v_permlane32_swap_b32 v88, v89
    s_cmp_ge_u32 s6, 2
    s_cbranch_scc1 F_fin1
    s_branch F_fin0
F_hc:
    s_sub_u32 s6, s5, 4
    v_lshlrev_b32 v1, 4, v0
    v_lshrrev_b32 v2, 3, v0
    v_and_b32 v223, 7, v0
    v_lshlrev_b32 v223, 4, v223
    v_lshl_add_u32 v223, v2, 10, v223
    v_lshrrev_b32 v4, 3, v0
    v_lshrrev_b32 v5, 2, v4
    v_xor_b32 v6, 0, v5
    v_lshlrev_b32 v6, 2, v6
    v_lshl_add_u32 v6, v5, 3, v6
    v_and_b32 v7, 3, v4
    v_add3_u32 v6, v6, v7, 0
    v_lshlrev_b32 v219, 12, v6
    v_lshrrev_b32 v6, 1, v4
    v_add_u32 v6, 0, v6
    v_and_b32 v7, 7, v0
    v_xor_b32 v6, v6, v7
    v_lshl_add_u32 v219, v6, 4, v219
    v_xor_b32 v6, 0, v5
    v_lshlrev_b32 v6, 2, v6
    v_lshl_add_u32 v6, v5, 3, v6
    v_and_b32 v7, 3, v4
    v_add3_u32 v6, v6, v7, 16
    v_lshlrev_b32 v220, 12, v6
    v_lshrrev_b32 v6, 1, v4
    v_add_u32 v6, 4, v6
    v_and_b32 v7, 7, v0
    v_xor_b32 v6, v6, v7
    v_lshl_add_u32 v220, v6, 4, v220
    v_xor_b32 v6, 1, v5
    v_lshlrev_b32 v6, 2, v6
    v_lshl_add_u32 v6, v5, 3, v6
    v_and_b32 v7, 3, v4
    v_add3_u32 v6, v6, v7, 0
    v_lshlrev_b32 v221, 12, v6
    v_lshrrev_b32 v6, 1, v4
    v_add_u32 v6, 0, v6
    v_and_b32 v7, 7, v0
    v_xor_b32 v6, v6, v7
    v_lshl_add_u32 v221, v6, 4, v221
    v_xor_b32 v6, 1, v5
    v_lshlrev_b32 v6, 2, v6
    v_lshl_add_u32 v6, v5, 3, v6
    v_and_b32 v7, 3, v4
    v_add3_u32 v6, v6, v7, 16
    v_lshlrev_b32 v222, 12, v6
    v_lshrrev_b32 v6, 1, v4
    v_add_u32 v6, 4, v6
    v_and_b32 v7, 7, v0
    v_xor_b32 v6, v6, v7
    v_lshl_add_u32 v222, v6, 4, v222
    v_lshrrev_b32 v2, 2, v0
    v_and_b32 v3, 3, v0
    v_lshlrev_b32 v2, 7, v2
    v_lshl_add_u32 v226, v3, 2, v2
    v_and_b32 v2, 15, v0
    v_lshrrev_b32 v3, 1, v2
    v_lshrrev_b32 v204, 4, v0
    v_xor_b32 v204, v204, v3
    v_lshlrev_b32 v204, 4, v204
    v_lshl_add_u32 v204, v2, 7, v204
    s_lshl_b32 s66, s6, 12
    v_add_u32 v204, s66, v204
    v_add_u32 v205, 16384, v1
    v_mov_b32 v206, v204
    v_mov_b32 v208, v205
    v_xor_b32 v207, 64, v204
    v_bfe_u32 v2, v0, 2, 2
    v_and_b32 v210, 1, v2
    v_lshlrev_b32 v210, 2, v210
    v_lshl_add_u32 v210, v2, 3, v210
    v_and_b32 v2, 3, v0
    v_add_u32 v210, v210, v2
    v_lshrrev_b32 v2, 4, v0
    v_and_b32 v3, 15, v0
    v_lshlrev_b32 v3, 3, v3
    v_lshl_add_u32 v128, v2, 10, v3
    v_add_u32 v129, 106496, v128
    s_and_b32 s64, s2, 7
    v_lshrrev_b32 v2, 3, v0
    v_add_u32 v2, s64, v2
    v_and_b32 v2, 7, v2
    v_and_b32 v3, 7, v0
    v_lshl_add_u32 v2, v2, 5, v3
    v_lshlrev_b32 v213, 7, v2
    s_lshl_b32 s64, s64, 12
    v_lshl_add_u32 v212, v3, 7, s64
    v_and_b32 v2, 15, v0
    v_lshrrev_b32 v3, 4, v0
    v_lshlrev_b32 v2, 4, v2
    v_lshl_add_u32 v215, v3, 12, v2
    s_mul_i32 s64, s6, 7168
    v_add_u32 v214, s64, v1
    v_and_b32 v2, 3, v0
    v_bfe_u32 v3, v0, 2, 2
    v_lshrrev_b32 v4, 4, v0
    v_lshl_add_u32 v5, v3, 4, v2
    v_lshl_add_u32 v5, v4, 2, v5
    v_lshl_add_u32 v6, v2, 2, v3
    v_lshl_add_u32 v6, v4, 4, v6
    v_lshl_add_u32 v216, v5, 4, s64
    v_lshl_add_u32 v6, v6, 4, s64
    v_and_b32 v4, 1, v4
    v_lshl_add_u32 v217, v4, 3, v6
    v_xor_b32 v218, 8, v217
    s_cmp_eq_u32 s6, 1
    s_cbranch_scc1 F_hm1
    s_cmp_eq_u32 s6, 2
    s_cbranch_scc1 F_hm2
    s_cmp_eq_u32 s6, 3
    s_cbranch_scc1 F_hm3
F_hm0:
    s_lshr_b32 s64, s4, 1
    s_mul_i32 s64, s64, 448
    s_and_b32 s65, s4, 1
    s_mul_i32 s65, s65, 3584
    s_add_u32 s65, s65, s64
    v_add_u32 v2, 0, v0
    v_mul_u32_u24 v3, 4682, v2
    v_lshrrev_b32 v3, 16, v3
    v_mul_u32_u24 v4, 14, v3
    v_sub_u32 v4, v2, v4
    v_bfe_u32 v5, v3, 2, 2
    v_lshrrev_b32 v6, 4, v3
    v_and_b32 v3, 3, v3
    v_lshl_add_u32 v3, v5, 3, v3
    v_lshl_add_u32 v3, v6, 2, v3
    v_mul_u32_u24 v3, 7168, v3
    v_lshl_add_u32 v3, v4, 4, v3
    v_add_u32 v184, s65, v3
    v_add_u32 v185, 224, v184
    v_add_u32 v2, 64, v0
    v_mul_u32_u24 v3, 4682, v2
    v_lshrrev_b32 v3, 16, v3
    v_mul_u32_u24 v4, 14, v3
    v_sub_u32 v4, v2, v4
    v_bfe_u32 v5, v3, 2, 2
    v_lshrrev_b32 v6, 4, v3
    v_and_b32 v3, 3, v3
    v_lshl_add_u32 v3, v5, 3, v3
    v_lshl_add_u32 v3, v6, 2, v3
    v_mul_u32_u24 v3, 7168, v3
    v_lshl_add_u32 v3, v4, 4, v3
    v_add_u32 v186, s65, v3
    v_add_u32 v187, 224, v186
    v_add_u32 v2, 128, v0
    v_mul_u32_u24 v3, 4682, v2
    v_lshrrev_b32 v3, 16, v3
    v_mul_u32_u24 v4, 14, v3
    v_sub_u32 v4, v2, v4
    v_bfe_u32 v5, v3, 2, 2
    v_lshrrev_b32 v6, 4, v3
    v_and_b32 v3, 3, v3
    v_lshl_add_u32 v3, v5, 3, v3
    v_lshl_add_u32 v3, v6, 2, v3
    v_mul_u32_u24 v3, 7168, v3
    v_lshl_add_u32 v3, v4, 4, v3
    v_add_u32 v188, s65, v3
    v_add_u32 v189, 224, v188
    v_add_u32 v2, 192, v0
    v_mul_u32_u24 v3, 4682, v2
    v_lshrrev_b32 v3, 16, v3
    v_mul_u32_u24 v4, 14, v3
    v_sub_u32 v4, v2, v4
    v_bfe_u32 v5, v3, 2, 2
    v_lshrrev_b32 v6, 4, v3
    v_and_b32 v3, 3, v3
    v_lshl_add_u32 v3, v5, 3, v3
    v_lshl_add_u32 v3, v6, 2, v3
    v_mul_u32_u24 v3, 7168, v3
    v_lshl_add_u32 v3, v4, 4, v3
    v_add_u32 v190, s65, v3
    s_mov_b32 s59, 49152
    s_mov_b32 s60, 0
    s_mov_b32 s61, 0
    s_lshl_b32 s62, s3, 18
    s_mov_b32 s58, 3
F_pp0:
    s_add_u32 m0, s59, 4096
    s_nop 0
    buffer_load_dwordx4 v184, s[16:19], s61 offen lds
    s_add_u32 m0, s59, 11264
    s_nop 0
    buffer_load_dwordx4 v185, s[16:19], s61 offen lds
    s_add_u32 m0, s59, 5120
    s_nop 0
    buffer_load_dwordx4 v186, s[16:19], s61 offen lds
    s_add_u32 m0, s59, 12288
    s_nop 0
    buffer_load_dwordx4 v187, s[16:19], s61 offen lds
    s_add_u32 m0, s59, 6144
    s_nop 0
    buffer_load_dwordx4 v188, s[16:19], s61 offen lds
    s_add_u32 m0, s59, 13312
    s_nop 0
    buffer_load_dwordx4 v189, s[16:19], s61 offen lds
    s_add_u32 m0, s59, 7168
    s_nop 0
    buffer_load_dwordx4 v190, s[16:19], s61 offen lds
    s_add_u32 s61, s61, 229376
    s_add_u32 s59, s59, 19456
    s_cmp_eq_u32 s59, 146432
    s_cselect_b32 s59, 49152, s59
    s_sub_u32 s58, s58, 1
    s_cmp_lg_u32 s58, 0
    s_cbranch_scc1 F_pp0
    s_lshr_b32 s73, s2, 1
    s_lshl_b32 s73, s73, 7
    s_and_b32 s64, s2, 1
    s_lshl_b32 s64, s64, 6
    s_add_u32 s73, s73, s64
    s_add_u32 s72, s73, 589824
    s_add_u32 s73, s73, 3145728
    s_setprio 3
    s_mov_b32 s58, 14
F_pl0:
    s_waitcnt vmcnt(14)
    s_barrier
    s_buffer_load_dword s68, s[16:19], s73 offset:0
    s_buffer_load_dword s68, s[16:19], s73 offset:16384
    s_buffer_load_dword s68, s[16:19], s73 offset:32768
    s_buffer_load_dword s68, s[16:19], s73 offset:49152
    s_buffer_load_dword s68, s[16:19], s73 offset:65536
    s_buffer_load_dword s68, s[16:19], s73 offset:81920
    s_add_u32 s73, s73, 163840
    s_add_u32 m0, s59, 4096
    s_nop 0
    buffer_load_dwordx4 v184, s[16:19], s61 offen lds
    s_add_u32 m0, s59, 11264
    s_nop 0
    buffer_load_dwordx4 v185, s[16:19], s61 offen lds
    s_add_u32 m0, s59, 5120
    s_nop 0
    buffer_load_dwordx4 v186, s[16:19], s61 offen lds
    s_add_u32 m0, s59, 12288
    s_nop 0
    buffer_load_dwordx4 v187, s[16:19], s61 offen lds
    s_add_u32 m0, s59, 6144
    s_nop 0
    buffer_load_dwordx4 v188, s[16:19], s61 offen lds
    s_add_u32 m0, s59, 13312
    s_nop 0
    buffer_load_dwordx4 v189, s[16:19], s61 offen lds
    s_add_u32 m0, s59, 7168
    s_nop 0
    buffer_load_dwordx4 v190, s[16:19], s61 offen lds
    s_add_u32 s61, s61, 229376
    s_add_u32 s59, s59, 19456
    s_cmp_eq_u32 s59, 146432
    s_cselect_b32 s59, 49152, s59
    s_waitcnt vmcnt(14)
    s_barrier
    s_buffer_load_dword s68, s[16:19], s73 offset:0
    s_buffer_load_dword s68, s[16:19], s73 offset:16384
    s_buffer_load_dword s68, s[16:19], s73 offset:32768
    s_buffer_load_dword s68, s[16:19], s73 offset:49152
    s_buffer_load_dword s68, s[16:19], s73 offset:65536
    s_buffer_load_dword s68, s[16:19], s73 offset:81920
    s_add_u32 s73, s73, 163840
    s_add_u32 m0, s59, 4096
    s_nop 0
    buffer_load_dwordx4 v184, s[16:19], s61 offen lds
    s_add_u32 m0, s59, 11264
    s_nop 0
    buffer_load_dwordx4 v185, s[16:19], s61 offen lds
    s_add_u32 m0, s59, 5120
    s_nop 0
    buffer_load_dwordx4 v186, s[16:19], s61 offen lds
    s_add_u32 m0, s59, 12288
    s_nop 0
    buffer_load_dwordx4 v187, s[16:19], s61 offen lds
    s_add_u32 m0, s59, 6144
    s_nop 0
    buffer_load_dwordx4 v188, s[16:19], s61 offen lds
    s_add_u32 m0, s59, 13312
    s_nop 0
    buffer_load_dwordx4 v189, s[16:19], s61 offen lds
    s_add_u32 m0, s59, 7168
    s_nop 0
    buffer_load_dwordx4 v190, s[16:19], s61 offen lds
    s_add_u32 s61, s61, 229376
    s_add_u32 s59, s59, 19456
    s_cmp_eq_u32 s59, 146432
    s_cselect_b32 s59, 49152, s59
    s_sub_u32 s58, s58, 1
    s_cmp_lg_u32 s58, 0
    s_cbranch_scc1 F_pl0
    v_and_b32 v2, 15, v0
    v_lshlrev_b32 v2, 4, v2
    v_lshrrev_b32 v4, 4, v0
    v_lshl_add_u32 v3, v4, 11, v2
    s_lshl_b32 s7, s3, 4
    s_add_u32 s7, s7, s4
    s_lshl_b32 s7, s7, 3
    s_add_u32 s7, s7, 0
    s_lshl_b32 s64, s7, 11
    s_waitcnt vmcnt(14)
    s_barrier
    s_add_u32 m0, s59, 4096
    s_nop 0
    buffer_load_dwordx4 v184, s[16:19], s61 offen lds
    s_add_u32 m0, s59, 11264
    s_nop 0
    buffer_load_dwordx4 v185, s[16:19], s61 offen lds
    s_add_u32 m0, s59, 5120
    s_nop 0
    buffer_load_dwordx4 v186, s[16:19], s61 offen lds
    s_add_u32 m0, s59, 12288
    s_nop 0
    buffer_load_dwordx4 v187, s[16:19], s61 offen lds
    s_add_u32 m0, s59, 6144
    s_nop 0
    buffer_load_dwordx4 v188, s[16:19], s61 offen lds
    s_add_u32 m0, s59, 13312
    s_nop 0
    buffer_load_dwordx4 v189, s[16:19], s61 offen lds
    s_add_u32 m0, s59, 7168
    s_nop 0
    buffer_load_dwordx4 v190, s[16:19], s61 offen lds
    s_add_u32 s61, s61, 229376
    s_add_u32 s59, s59, 19456
    s_cmp_eq_u32 s59, 146432
    s_cselect_b32 s59, 49152, s59
    s_waitcnt vmcnt(14)
    s_barrier
    buffer_load_dwordx4 v[132:135], v3, s[8:11], s64 offen offset:0
    buffer_load_dwordx4 v[92:95], v2, s[36:39], 0 offen offset:0
    buffer_load_dwordx4 v[136:139], v3, s[8:11], s64 offen offset:256
    buffer_load_dwordx4 v[96:99], v2, s[36:39], 0 offen offset:256
    buffer_load_dwordx4 v[140:143], v3, s[8:11], s64 offen offset:512
    buffer_load_dwordx4 v[100:103], v2, s[36:39], 0 offen offset:512
    buffer_load_dwordx4 v[144:147], v3, s[8:11], s64 offen offset:768
    buffer_load_dwordx4 v[104:107], v2, s[36:39], 0 offen offset:768
    s_waitcnt vmcnt(15)
    s_barrier
    buffer_load_dwordx4 v[148:151], v3, s[8:11], s64 offen offset:1024
    buffer_load_dwordx4 v[108:111], v2, s[36:39], 0 offen offset:1024
    buffer_load_dwordx4 v[152:155], v3, s[8:11], s64 offen offset:1280
    buffer_load_dwordx4 v[112:115], v2, s[36:39], 0 offen offset:1280
    buffer_load_dwordx4 v[156:159], v3, s[8:11], s64 offen offset:1536
    buffer_load_dwordx4 v[116:119], v2, s[36:39], 0 offen offset:1536
    buffer_load_dwordx4 v[160:163], v3, s[8:11], s64 offen offset:1792
    buffer_load_dwordx4 v[120:123], v2, s[36:39], 0 offen offset:1792
    s_waitcnt vmcnt(16)
    s_barrier
    s_waitcnt lgkmcnt(0)
    s_setprio 3
    s_barrier
    s_waitcnt vmcnt(0)
    v_mov_b32 v8, 0
    v_mov_b32 v9, 0
    v_dot2c_f32_bf16 v8, v132, v92
    v_dot2c_f32_bf16 v9, v133, v93
    v_dot2c_f32_bf16 v8, v134, v94
    v_dot2c_f32_bf16 v9, v135, v95
    v_dot2c_f32_bf16 v8, v136, v96
    v_dot2c_f32_bf16 v9, v137, v97
    v_dot2c_f32_bf16 v8, v138, v98
    v_dot2c_f32_bf16 v9, v139, v99
    v_dot2c_f32_bf16 v8, v140, v100
    v_dot2c_f32_bf16 v9, v141, v101
    v_dot2c_f32_bf16 v8, v142, v102
    v_dot2c_f32_bf16 v9, v143, v103
    v_dot2c_f32_bf16 v8, v144, v104
    v_dot2c_f32_bf16 v9, v145, v105
    v_dot2c_f32_bf16 v8, v146, v106
    v_dot2c_f32_bf16 v9, v147, v107
    v_dot2c_f32_bf16 v8, v148, v108
    v_dot2c_f32_bf16 v9, v149, v109
    v_dot2c_f32_bf16 v8, v150, v110
    v_dot2c_f32_bf16 v9, v151, v111
    v_dot2c_f32_bf16 v8, v152, v112
    v_dot2c_f32_bf16 v9, v153, v113
    v_dot2c_f32_bf16 v8, v154, v114
    v_dot2c_f32_bf16 v9, v155, v115
    v_dot2c_f32_bf16 v8, v156, v116
    v_dot2c_f32_bf16 v9, v157, v117
    v_dot2c_f32_bf16 v8, v158, v118
    v_dot2c_f32_bf16 v9, v159, v119
    v_dot2c_f32_bf16 v8, v160, v120
    v_dot2c_f32_bf16 v9, v161, v121
    v_dot2c_f32_bf16 v8, v162, v122
    v_dot2c_f32_bf16 v9, v163, v123
    s_nop 2
    v_add_f32 v8, v8, v9
    s_nop 1
    v_add_f32_dpp v8, v8, v8 row_ror:8 row_mask:0xf bank_mask:0xf
    s_nop 1
    v_add_f32_dpp v8, v8, v8 row_ror:4 row_mask:0xf bank_mask:0xf
    s_nop 1
    v_add_f32_dpp v8, v8, v8 row_ror:2 row_mask:0xf bank_mask:0xf
    s_nop 1
    v_add_f32_dpp v8, v8, v8 row_ror:1 row_mask:0xf bank_mask:0xf
    v_mul_f32 v8, 0xbfb8aa3b, v8
    v_exp_f32 v8, v8
    s_nop 0
    v_add_f32 v8, 1.0, v8
    v_rcp_f32 v8, v8
    s_nop 0
    v_min_u32 v8, -2, v8
    s_lshl_b32 s7, s7, 2
    s_add_u32 s7, s7, 4718592
    v_lshlrev_b32 v9, 2, v4
    buffer_store_dword v8, v9, s[24:27], s7 offen sc1
    s_branch F_h2x
F_hm1:
    s_lshr_b32 s64, s4, 1
    s_mul_i32 s64, s64, 448
    s_and_b32 s65, s4, 1
    s_mul_i32 s65, s65, 3584
    s_add_u32 s65, s65, s64
    v_add_u32 v2, 192, v0
    v_mul_u32_u24 v3, 4682, v2
    v_lshrrev_b32 v3, 16, v3
    v_mul_u32_u24 v4, 14, v3
    v_sub_u32 v4, v2, v4
    v_bfe_u32 v5, v3, 2, 2
    v_lshrrev_b32 v6, 4, v3
    v_and_b32 v3, 3, v3
    v_lshl_add_u32 v3, v5, 3, v3
    v_lshl_add_u32 v3, v6, 2, v3
    v_mul_u32_u24 v3, 7168, v3
    v_lshl_add_u32 v3, v4, 4, v3
    v_add_u32 v184, s65, v3
    v_add_u32 v184, 224, v184
    v_add_u32 v2, 256, v0
    v_mul_u32_u24 v3, 4682, v2
    v_lshrrev_b32 v3, 16, v3
    v_mul_u32_u24 v4, 14, v3
    v_sub_u32 v4, v2, v4
    v_bfe_u32 v5, v3, 2, 2
    v_lshrrev_b32 v6, 4, v3
    v_and_b32 v3, 3, v3
    v_lshl_add_u32 v3, v5, 3, v3
    v_lshl_add_u32 v3, v6, 2, v3
    v_mul_u32_u24 v3, 7168, v3
    v_lshl_add_u32 v3, v4, 4, v3
    v_add_u32 v185, s65, v3
    v_add_u32 v186, 224, v185
    v_add_u32 v2, 320, v0
    v_mul_u32_u24 v3, 4682, v2
    v_lshrrev_b32 v3, 16, v3
    v_mul_u32_u24 v4, 14, v3
    v_sub_u32 v4, v2, v4
    v_bfe_u32 v5, v3, 2, 2
    v_lshrrev_b32 v6, 4, v3
    v_and_b32 v3, 3, v3
    v_lshl_add_u32 v3, v5, 3, v3
    v_lshl_add_u32 v3, v6, 2, v3
    v_mul_u32_u24 v3, 7168, v3
    v_lshl_add_u32 v3, v4, 4, v3
    v_add_u32 v187, s65, v3
    v_add_u32 v188, 224, v187
    v_add_u32 v2, 384, v0
    v_mul_u32_u24 v3, 4682, v2
    v_lshrrev_b32 v3, 16, v3
    v_mul_u32_u24 v4, 14, v3
    v_sub_u32 v4, v2, v4
    v_bfe_u32 v5, v3, 2, 2
    v_lshrrev_b32 v6, 4, v3
    v_and_b32 v3, 3, v3
    v_lshl_add_u32 v3, v5, 3, v3
    v_lshl_add_u32 v3, v6, 2, v3
    v_mul_u32_u24 v3, 7168, v3
    v_lshl_add_u32 v3, v4, 4, v3
    v_add_u32 v189, s65, v3
    v_add_u32 v190, 224, v189
    s_mov_b32 s59, 49152
    s_mov_b32 s60, 0
    s_mov_b32 s61, 0
    s_lshl_b32 s62, s3, 18
    s_mov_b32 s58, 3
F_pp1:
    s_add_u32 m0, s59, 14336
    s_nop 0
    buffer_load_dwordx4 v184, s[16:19], s61 offen lds
    s_add_u32 m0, s59, 8192
    s_nop 0
    buffer_load_dwordx4 v185, s[16:19], s61 offen lds
    s_add_u32 m0, s59, 15360
    s_nop 0
    buffer_load_dwordx4 v186, s[16:19], s61 offen lds
    s_add_u32 m0, s59, 9216
    s_nop 0
    buffer_load_dwordx4 v187, s[16:19], s61 offen lds
    s_add_u32 m0, s59, 16384
    s_nop 0
    buffer_load_dwordx4 v188, s[16:19], s61 offen lds
    s_add_u32 m0, s59, 10240
    s_nop 0
    buffer_load_dwordx4 v189, s[16:19], s61 offen lds
    s_add_u32 m0, s59, 17408
    s_nop 0
    buffer_load_dwordx4 v190, s[16:19], s61 offen lds
    s_add_u32 s61, s61, 229376
    s_add_u32 s59, s59, 19456
    s_cmp_eq_u32 s59, 146432
    s_cselect_b32 s59, 49152, s59
    s_sub_u32 s58, s58, 1
    s_cmp_lg_u32 s58, 0
    s_cbranch_scc1 F_pp1
    s_lshr_b32 s73, s2, 1
    s_lshl_b32 s73, s73, 15
    s_and_b32 s64, s2, 1
    s_lshl_b32 s64, s64, 6
    s_add_u32 s73, s73, s64
    s_add_u32 s72, s73, 589824
    s_add_u32 s73, s73, 512
    s_setprio 3
    s_mov_b32 s58, 14
F_pl1:
    s_waitcnt vmcnt(14)
    s_barrier
    s_buffer_load_dword s68, s[8:11], s73 offset:0
    s_buffer_load_dword s68, s[8:11], s73 offset:2048
    s_buffer_load_dword s68, s[8:11], s73 offset:4096
    s_buffer_load_dword s68, s[8:11], s73 offset:6144
    s_buffer_load_dword s68, s[8:11], s73 offset:8192
    s_buffer_load_dword s68, s[8:11], s73 offset:10240
    s_buffer_load_dword s68, s[8:11], s73 offset:12288
    s_buffer_load_dword s68, s[8:11], s73 offset:14336
    s_add_u32 m0, s59, 14336
    s_nop 0
    buffer_load_dwordx4 v184, s[16:19], s61 offen lds
    s_add_u32 m0, s59, 8192
    s_nop 0
    buffer_load_dwordx4 v185, s[16:19], s61 offen lds
    s_add_u32 m0, s59, 15360
    s_nop 0
    buffer_load_dwordx4 v186, s[16:19], s61 offen lds
    s_add_u32 m0, s59, 9216
    s_nop 0
    buffer_load_dwordx4 v187, s[16:19], s61 offen lds
    s_add_u32 m0, s59, 16384
    s_nop 0
    buffer_load_dwordx4 v188, s[16:19], s61 offen lds
    s_add_u32 m0, s59, 10240
    s_nop 0
    buffer_load_dwordx4 v189, s[16:19], s61 offen lds
    s_add_u32 m0, s59, 17408
    s_nop 0
    buffer_load_dwordx4 v190, s[16:19], s61 offen lds
    s_add_u32 s61, s61, 229376
    s_add_u32 s59, s59, 19456
    s_cmp_eq_u32 s59, 146432
    s_cselect_b32 s59, 49152, s59
    s_waitcnt vmcnt(14)
    s_barrier
    s_buffer_load_dword s68, s[8:11], s73 offset:16384
    s_buffer_load_dword s68, s[8:11], s73 offset:18432
    s_buffer_load_dword s68, s[8:11], s73 offset:20480
    s_buffer_load_dword s68, s[8:11], s73 offset:22528
    s_buffer_load_dword s68, s[8:11], s73 offset:24576
    s_buffer_load_dword s68, s[8:11], s73 offset:26624
    s_buffer_load_dword s68, s[8:11], s73 offset:28672
    s_buffer_load_dword s68, s[8:11], s73 offset:30720
    s_add_u32 s73, s73, 128
    s_cmp_eq_u32 s58, 3
    s_cselect_b32 s73, 0x1000000, s73
    s_add_u32 m0, s59, 14336
    s_nop 0
    buffer_load_dwordx4 v184, s[16:19], s61 offen lds
    s_add_u32 m0, s59, 8192
    s_nop 0
    buffer_load_dwordx4 v185, s[16:19], s61 offen lds
    s_add_u32 m0, s59, 15360
    s_nop 0
    buffer_load_dwordx4 v186, s[16:19], s61 offen lds
    s_add_u32 m0, s59, 9216
    s_nop 0
    buffer_load_dwordx4 v187, s[16:19], s61 offen lds
    s_add_u32 m0, s59, 16384
    s_nop 0
    buffer_load_dwordx4 v188, s[16:19], s61 offen lds
    s_add_u32 m0, s59, 10240
    s_nop 0
    buffer_load_dwordx4 v189, s[16:19], s61 offen lds
    s_add_u32 m0, s59, 17408
    s_nop 0
    buffer_load_dwordx4 v190, s[16:19], s61 offen lds
    s_add_u32 s61, s61, 229376
    s_add_u32 s59, s59, 19456
    s_cmp_eq_u32 s59, 146432
    s_cselect_b32 s59, 49152, s59
    s_sub_u32 s58, s58, 1
    s_cmp_lg_u32 s58, 0
    s_cbranch_scc1 F_pl1
    v_and_b32 v2, 15, v0
    v_lshlrev_b32 v2, 4, v2
    v_lshrrev_b32 v4, 4, v0
    v_lshl_add_u32 v3, v4, 11, v2
    s_lshl_b32 s7, s3, 4
    s_add_u32 s7, s7, s4
    s_lshl_b32 s7, s7, 3
    s_add_u32 s7, s7, 4
    s_lshl_b32 s64, s7, 11
    s_waitcnt vmcnt(14)
    s_barrier
    s_add_u32 m0, s59, 14336
    s_nop 0
    buffer_load_dwordx4 v184, s[16:19], s61 offen lds
    s_add_u32 m0, s59, 8192
    s_nop 0
    buffer_load_dwordx4 v185, s[16:19], s61 offen lds
    s_add_u32 m0, s59, 15360
    s_nop 0
    buffer_load_dwordx4 v186, s[16:19], s61 offen lds
    s_add_u32 m0, s59, 9216
    s_nop 0
    buffer_load_dwordx4 v187, s[16:19], s61 offen lds
    s_add_u32 m0, s59, 16384
    s_nop 0
    buffer_load_dwordx4 v188, s[16:19], s61 offen lds
    s_add_u32 m0, s59, 10240
    s_nop 0
    buffer_load_dwordx4 v189, s[16:19], s61 offen lds
    s_add_u32 m0, s59, 17408
    s_nop 0
    buffer_load_dwordx4 v190, s[16:19], s61 offen lds
    s_add_u32 s61, s61, 229376
    s_add_u32 s59, s59, 19456
    s_cmp_eq_u32 s59, 146432
    s_cselect_b32 s59, 49152, s59
    s_waitcnt vmcnt(14)
    s_barrier
    buffer_load_dwordx4 v[132:135], v3, s[8:11], s64 offen offset:0
    buffer_load_dwordx4 v[92:95], v2, s[36:39], 0 offen offset:0
    buffer_load_dwordx4 v[136:139], v3, s[8:11], s64 offen offset:256
    buffer_load_dwordx4 v[96:99], v2, s[36:39], 0 offen offset:256
    buffer_load_dwordx4 v[140:143], v3, s[8:11], s64 offen offset:512
    buffer_load_dwordx4 v[100:103], v2, s[36:39], 0 offen offset:512
    buffer_load_dwordx4 v[144:147], v3, s[8:11], s64 offen offset:768
    buffer_load_dwordx4 v[104:107], v2, s[36:39], 0 offen offset:768
    s_waitcnt vmcnt(15)
    s_barrier
    buffer_load_dwordx4 v[148:151], v3, s[8:11], s64 offen offset:1024
    buffer_load_dwordx4 v[108:111], v2, s[36:39], 0 offen offset:1024
    buffer_load_dwordx4 v[152:155], v3, s[8:11], s64 offen offset:1280
    buffer_load_dwordx4 v[112:115], v2, s[36:39], 0 offen offset:1280
    buffer_load_dwordx4 v[156:159], v3, s[8:11], s64 offen offset:1536
    buffer_load_dwordx4 v[116:119], v2, s[36:39], 0 offen offset:1536
    buffer_load_dwordx4 v[160:163], v3, s[8:11], s64 offen offset:1792
    buffer_load_dwordx4 v[120:123], v2, s[36:39], 0 offen offset:1792
    s_waitcnt vmcnt(16)
    s_barrier
    s_waitcnt lgkmcnt(0)
    s_setprio 3
    s_barrier
    s_waitcnt vmcnt(0)
    v_mov_b32 v8, 0
    v_mov_b32 v9, 0
    v_dot2c_f32_bf16 v8, v132, v92
    v_dot2c_f32_bf16 v9, v133, v93
    v_dot2c_f32_bf16 v8, v134, v94
    v_dot2c_f32_bf16 v9, v135, v95
    v_dot2c_f32_bf16 v8, v136, v96
    v_dot2c_f32_bf16 v9, v137, v97
    v_dot2c_f32_bf16 v8, v138, v98
    v_dot2c_f32_bf16 v9, v139, v99
    v_dot2c_f32_bf16 v8, v140, v100
    v_dot2c_f32_bf16 v9, v141, v101
    v_dot2c_f32_bf16 v8, v142, v102
    v_dot2c_f32_bf16 v9, v143, v103
    v_dot2c_f32_bf16 v8, v144, v104
    v_dot2c_f32_bf16 v9, v145, v105
    v_dot2c_f32_bf16 v8, v146, v106
    v_dot2c_f32_bf16 v9, v147, v107
    v_dot2c_f32_bf16 v8, v148, v108
    v_dot2c_f32_bf16 v9, v149, v109
    v_dot2c_f32_bf16 v8, v150, v110
    v_dot2c_f32_bf16 v9, v151, v111
    v_dot2c_f32_bf16 v8, v152, v112
    v_dot2c_f32_bf16 v9, v153, v113
    v_dot2c_f32_bf16 v8, v154, v114
    v_dot2c_f32_bf16 v9, v155, v115
    v_dot2c_f32_bf16 v8, v156, v116
    v_dot2c_f32_bf16 v9, v157, v117
    v_dot2c_f32_bf16 v8, v158, v118
    v_dot2c_f32_bf16 v9, v159, v119
    v_dot2c_f32_bf16 v8, v160, v120
    v_dot2c_f32_bf16 v9, v161, v121
    v_dot2c_f32_bf16 v8, v162, v122
    v_dot2c_f32_bf16 v9, v163, v123
    s_nop 2
    v_add_f32 v8, v8, v9
    s_nop 1
    v_add_f32_dpp v8, v8, v8 row_ror:8 row_mask:0xf bank_mask:0xf
    s_nop 1
    v_add_f32_dpp v8, v8, v8 row_ror:4 row_mask:0xf bank_mask:0xf
    s_nop 1
    v_add_f32_dpp v8, v8, v8 row_ror:2 row_mask:0xf bank_mask:0xf
    s_nop 1
    v_add_f32_dpp v8, v8, v8 row_ror:1 row_mask:0xf bank_mask:0xf
    v_mul_f32 v8, 0xbfb8aa3b, v8
    v_exp_f32 v8, v8
    s_nop 0
    v_add_f32 v8, 1.0, v8
    v_rcp_f32 v8, v8
    s_nop 0
    v_min_u32 v8, -2, v8
    s_lshl_b32 s7, s7, 2
    s_add_u32 s7, s7, 4718592
    v_lshlrev_b32 v9, 2, v4
    buffer_store_dword v8, v9, s[24:27], s7 offen sc1
    s_branch F_h2x
F_hm2:
    v_lshrrev_b32 v2, 3, v0
    v_lshrrev_b32 v3, 2, v2
    v_xor_b32 v4, 0, v3
    v_lshlrev_b32 v4, 2, v4
    v_lshl_add_u32 v4, v3, 3, v4
    v_and_b32 v5, 3, v2
    v_add3_u32 v4, v4, v5, 0
    v_lshlrev_b32 v184, 11, v4
    v_lshrrev_b32 v4, 1, v2
    v_add_u32 v4, 0, v4
    v_and_b32 v5, 7, v0
    v_xor_b32 v4, v4, v5
    v_lshl_add_u32 v184, v4, 4, v184
    v_xor_b32 v4, 0, v3
    v_lshlrev_b32 v4, 2, v4
    v_lshl_add_u32 v4, v3, 3, v4
    v_and_b32 v5, 3, v2
    v_add3_u32 v4, v4, v5, 16
    v_lshlrev_b32 v185, 11, v4
    v_lshrrev_b32 v4, 1, v2
    v_add_u32 v4, 4, v4
    v_and_b32 v5, 7, v0
    v_xor_b32 v4, v4, v5
    v_lshl_add_u32 v185, v4, 4, v185
    v_xor_b32 v4, 1, v3
    v_lshlrev_b32 v4, 2, v4
    v_lshl_add_u32 v4, v3, 3, v4
    v_and_b32 v5, 3, v2
    v_add3_u32 v4, v4, v5, 0
    v_lshlrev_b32 v186, 11, v4
    v_lshrrev_b32 v4, 1, v2
    v_add_u32 v4, 0, v4
    v_and_b32 v5, 7, v0
    v_xor_b32 v4, v4, v5
    v_lshl_add_u32 v186, v4, 4, v186
    v_xor_b32 v4, 1, v3
    v_lshlrev_b32 v4, 2, v4
    v_lshl_add_u32 v4, v3, 3, v4
    v_and_b32 v5, 3, v2
    v_add3_u32 v4, v4, v5, 16
    v_lshlrev_b32 v187, 11, v4
    v_lshrrev_b32 v4, 1, v2
    v_add_u32 v4, 4, v4
    v_and_b32 v5, 7, v0
    v_xor_b32 v4, v4, v5
    v_lshl_add_u32 v187, v4, 4, v187
    v_lshrrev_b32 v2, 3, v0
    v_lshrrev_b32 v3, 2, v2
    v_and_b32 v2, 3, v2
    v_lshl_add_u32 v2, v3, 3, v2
    v_lshlrev_b32 v2, 11, v2
    v_bfe_u32 v3, v0, 1, 2
    v_lshrrev_b32 v4, 4, v0
    v_xor_b32 v3, v3, v4
    v_lshl_add_u32 v2, v3, 5, v2
    v_and_b32 v3, 1, v0
    v_lshl_add_u32 v2, v3, 4, v2
    s_lshl_b32 s64, s4, 7
    v_add_u32 v188, s64, v2
    v_lshrrev_b32 v3, 1, v0
    v_bfe_u32 v5, v3, 2, 2
    v_lshrrev_b32 v6, 4, v3
    v_and_b32 v3, 3, v3
    v_lshl_add_u32 v3, v5, 3, v3
    v_lshl_add_u32 v3, v6, 2, v3
    v_lshlrev_b32 v3, 6, v3
    v_and_b32 v4, 1, v0
    v_lshl_add_u32 v3, v4, 4, v3
    s_and_b32 s64, s4, 1
    s_lshl_b32 s64, s64, 5
    v_add_u32 v189, s64, v3
    s_mov_b32 s59, 49152
    s_mov_b32 s60, 0
    s_mov_b32 s61, 0
    s_lshl_b32 s62, s3, 18
    s_mov_b32 s58, 1
F_pp2:
    s_add_u32 s64, s62, 0
    s_add_u32 m0, s60, 0
    s_nop 0
    buffer_load_dwordx4 v184, s[8:11], s64 offen lds
    s_add_u32 s64, s62, 0
    s_add_u32 m0, s60, 1024
    s_nop 0
    buffer_load_dwordx4 v185, s[8:11], s64 offen lds
    s_add_u32 s64, s62, 131072
    s_add_u32 m0, s60, 8192
    s_nop 0
    buffer_load_dwordx4 v184, s[8:11], s64 offen lds
    s_add_u32 s64, s62, 131072
    s_add_u32 m0, s60, 9216
    s_nop 0
    buffer_load_dwordx4 v185, s[8:11], s64 offen lds
    s_add_u32 s64, s61, 0
    s_add_u32 m0, s59, 0
    s_nop 0
    buffer_load_dwordx4 v188, s[12:15], s64 offen lds
    s_add_u32 s64, s61, 32768
    s_add_u32 m0, s59, 1024
    s_nop 0
    buffer_load_dwordx4 v188, s[12:15], s64 offen lds
    s_add_u32 s64, s61, 8192
    s_add_u32 m0, s59, 2048
    s_nop 0
    buffer_load_dwordx4 v188, s[12:15], s64 offen lds
    s_add_u32 s64, s61, 40960
    s_add_u32 m0, s59, 3072
    s_nop 0
    buffer_load_dwordx4 v188, s[12:15], s64 offen lds
    s_lshr_b32 s64, s61, 5
    s_add_u32 m0, s59, 18432
    s_nop 0
    buffer_load_dwordx4 v189, s[20:23], s64 offen lds
    s_add_u32 s61, s61, 65536
    s_add_u32 s59, s59, 19456
    s_cmp_eq_u32 s59, 146432
    s_cselect_b32 s59, 49152, s59
    s_add_u32 s60, s60, 16384
    s_cmp_eq_u32 s60, 49152
    s_cselect_b32 s60, 0, s60
    s_add_u32 s62, s62, 128
    s_add_u32 s64, s62, 0
    s_add_u32 m0, s60, 0
    s_nop 0
    buffer_load_dwordx4 v184, s[8:11], s64 offen lds
    s_add_u32 s64, s62, 0
    s_add_u32 m0, s60, 1024
    s_nop 0
    buffer_load_dwordx4 v185, s[8:11], s64 offen lds
    s_add_u32 s64, s61, 0
    s_add_u32 m0, s59, 0
    s_nop 0
    buffer_load_dwordx4 v188, s[12:15], s64 offen lds
    s_add_u32 s64, s61, 32768
    s_add_u32 m0, s59, 1024
    s_nop 0
    buffer_load_dwordx4 v188, s[12:15], s64 offen lds
    s_add_u32 s64, s61, 8192
    s_add_u32 m0, s59, 2048
    s_nop 0
    buffer_load_dwordx4 v188, s[12:15], s64 offen lds
    s_add_u32 s64, s61, 40960
    s_add_u32 m0, s59, 3072
    s_nop 0
    buffer_load_dwordx4 v188, s[12:15], s64 offen lds
    s_lshr_b32 s64, s61, 5
    s_add_u32 m0, s59, 18432
    s_nop 0
    buffer_load_dwordx4 v189, s[20:23], s64 offen lds
    s_add_u32 s61, s61, 65536
    s_add_u32 s59, s59, 19456
    s_cmp_eq_u32 s59, 146432
    s_cselect_b32 s59, 49152, s59
    s_add_u32 s64, s62, 131072
    s_add_u32 m0, s60, 8192
    s_nop 0
    buffer_load_dwordx4 v184, s[8:11], s64 offen lds
    s_add_u32 s64, s62, 131072
    s_add_u32 m0, s60, 9216
    s_nop 0
    buffer_load_dwordx4 v185, s[8:11], s64 offen lds
    s_add_u32 s64, s61, 0
    s_add_u32 m0, s59, 0
    s_nop 0
    buffer_load_dwordx4 v188, s[12:15], s64 offen lds
    s_add_u32 s64, s61, 32768
    s_add_u32 m0, s59, 1024
    s_nop 0
    buffer_load_dwordx4 v188, s[12:15], s64 offen lds
    s_add_u32 s64, s61, 8192
    s_add_u32 m0, s59, 2048
    s_nop 0
    buffer_load_dwordx4 v188, s[12:15], s64 offen lds
    s_add_u32 s64, s61, 40960
    s_add_u32 m0, s59, 3072
    s_nop 0
    buffer_load_dwordx4 v188, s[12:15], s64 offen lds
    s_lshr_b32 s64, s61, 5
    s_add_u32 m0, s59, 18432
    s_nop 0
    buffer_load_dwordx4 v189, s[20:23], s64 offen lds
    s_add_u32 s61, s61, 65536
    s_add_u32 s59, s59, 19456
    s_cmp_eq_u32 s59, 146432
    s_cselect_b32 s59, 49152, s59
    s_add_u32 s60, s60, 16384
    s_cmp_eq_u32 s60, 49152
    s_cselect_b32 s60, 0, s60
    s_add_u32 s62, s62, 128
    s_sub_u32 s58, s58, 1
    s_cmp_lg_u32 s58, 0
    s_cbranch_scc1 F_pp2
    s_lshr_b32 s73, s2, 1
    s_lshl_b32 s73, s73, 7
    s_and_b32 s64, s2, 1
    s_lshl_b32 s64, s64, 6
    s_add_u32 s73, s73, s64
    s_add_u32 s72, s73, 589824
    s_add_u32 s73, s73, 3145728
    s_setprio 3
    s_mov_b32 s58, 14
F_pl2:
    s_waitcnt vmcnt(14)
    s_barrier
    s_buffer_load_dword s68, s[16:19], s73 offset:98304
    s_buffer_load_dword s68, s[16:19], s73 offset:114688
    s_buffer_load_dword s68, s[16:19], s73 offset:131072
    s_buffer_load_dword s68, s[16:19], s73 offset:147456
    s_add_u32 s73, s73, 163840
    s_buffer_load_dword s68, s[12:15], s72 offset:0
    s_buffer_load_dword s68, s[12:15], s72 offset:16384
    s_buffer_load_dword s68, s[12:15], s72 offset:32768
    s_buffer_load_dword s68, s[12:15], s72 offset:49152
    s_add_u32 s72, s72, 65536
    s_add_u32 s64, s62, 0
    s_add_u32 m0, s60, 0
    s_nop 0
    buffer_load_dwordx4 v184, s[8:11], s64 offen lds
    s_add_u32 s64, s62, 0
    s_add_u32 m0, s60, 1024
    s_nop 0
    buffer_load_dwordx4 v185, s[8:11], s64 offen lds
    s_add_u32 s64, s61, 0
    s_add_u32 m0, s59, 0
    s_nop 0
    buffer_load_dwordx4 v188, s[12:15], s64 offen lds
    s_add_u32 s64, s61, 32768
    s_add_u32 m0, s59, 1024
    s_nop 0
    buffer_load_dwordx4 v188, s[12:15], s64 offen lds
    s_add_u32 s64, s61, 8192
    s_add_u32 m0, s59, 2048
    s_nop 0
    buffer_load_dwordx4 v188, s[12:15], s64 offen lds
    s_add_u32 s64, s61, 40960
    s_add_u32 m0, s59, 3072
    s_nop 0
    buffer_load_dwordx4 v188, s[12:15], s64 offen lds
    s_lshr_b32 s64, s61, 5
    s_add_u32 m0, s59, 18432
    s_nop 0
    buffer_load_dwordx4 v189, s[20:23], s64 offen lds
    s_add_u32 s61, s61, 65536
    s_add_u32 s59, s59, 19456
    s_cmp_eq_u32 s59, 146432
    s_cselect_b32 s59, 49152, s59
    s_waitcnt vmcnt(14)
    s_barrier
    s_buffer_load_dword s68, s[16:19], s73 offset:98304
    s_buffer_load_dword s68, s[16:19], s73 offset:114688
    s_buffer_load_dword s68, s[16:19], s73 offset:131072
    s_buffer_load_dword s68, s[16:19], s73 offset:147456
    s_add_u32 s73, s73, 163840
    s_buffer_load_dword s68, s[12:15], s72 offset:0
    s_buffer_load_dword s68, s[12:15], s72 offset:16384
    s_buffer_load_dword s68, s[12:15], s72 offset:32768
    s_buffer_load_dword s68, s[12:15], s72 offset:49152
    s_add_u32 s72, s72, 65536
    s_add_u32 s64, s62, 131072
    s_add_u32 m0, s60, 8192
    s_nop 0
    buffer_load_dwordx4 v184, s[8:11], s64 offen lds
    s_add_u32 s64, s62, 131072
    s_add_u32 m0, s60, 9216
    s_nop 0
    buffer_load_dwordx4 v185, s[8:11], s64 offen lds
    s_add_u32 s64, s61, 0
    s_add_u32 m0, s59, 0
    s_nop 0
    buffer_load_dwordx4 v188, s[12:15], s64 offen lds
    s_add_u32 s64, s61, 32768
    s_add_u32 m0, s59, 1024
    s_nop 0
    buffer_load_dwordx4 v188, s[12:15], s64 offen lds
    s_add_u32 s64, s61, 8192
    s_add_u32 m0, s59, 2048
    s_nop 0
    buffer_load_dwordx4 v188, s[12:15], s64 offen lds
    s_add_u32 s64, s61, 40960
    s_add_u32 m0, s59, 3072
    s_nop 0
    buffer_load_dwordx4 v188, s[12:15], s64 offen lds
    s_lshr_b32 s64, s61, 5
    s_add_u32 m0, s59, 18432
    s_nop 0
    buffer_load_dwordx4 v189, s[20:23], s64 offen lds
    s_add_u32 s61, s61, 65536
    s_add_u32 s59, s59, 19456
    s_cmp_eq_u32 s59, 146432
    s_cselect_b32 s59, 49152, s59
    s_add_u32 s60, s60, 16384
    s_cmp_eq_u32 s60, 49152
    s_cselect_b32 s60, 0, s60
    s_add_u32 s62, s62, 128
    s_sub_u32 s58, s58, 1
    s_cmp_lg_u32 s58, 0
    s_cbranch_scc1 F_pl2
    s_waitcnt vmcnt(14)
    s_barrier
    s_add_u32 s64, s61, 0
    s_add_u32 m0, s59, 0
    s_nop 0
    buffer_load_dwordx4 v188, s[12:15], s64 offen lds
    s_add_u32 s64, s61, 32768
    s_add_u32 m0, s59, 1024
    s_nop 0
    buffer_load_dwordx4 v188, s[12:15], s64 offen lds
    s_add_u32 s64, s61, 8192
    s_add_u32 m0, s59, 2048
    s_nop 0
    buffer_load_dwordx4 v188, s[12:15], s64 offen lds
    s_add_u32 s64, s61, 40960
    s_add_u32 m0, s59, 3072
    s_nop 0
    buffer_load_dwordx4 v188, s[12:15], s64 offen lds
    s_lshr_b32 s64, s61, 5
    s_add_u32 m0, s59, 18432
    s_nop 0
    buffer_load_dwordx4 v189, s[20:23], s64 offen lds
    s_add_u32 s61, s61, 65536
    s_add_u32 s59, s59, 19456
    s_cmp_eq_u32 s59, 146432
    s_cselect_b32 s59, 49152, s59
    v_and_b32 v152, 0xf0, v1
    buffer_load_dword v153, v152, s[52:55], 0 offen sc1
    s_getpc_b64 s[64:65]
F_pc5:
    s_sub_u32 s64, s64, F_pc5-gated_mix__grouped_kv_mqa__mixer_gmlp__prompt_kernel
    s_subb_u32 s65, s65, 0
    s_bfe_u32 s66, s2, 0x30003
    s_lshl_b32 s66, s66, 13
    v_lshl_add_u32 v2, v0, 7, s66
    v_min_u32 v2, F_exit-gated_mix__grouped_kv_mqa__mixer_gmlp__prompt_kernel, v2
    global_load_dword v2, v2, s[64:65]
    s_waitcnt vmcnt(14)
    s_barrier
    v_mov_b32 v4, -1
    v_mov_b32 v5, -1
    v_mov_b32 v6, -1
    v_mov_b32 v7, -1
    s_lshl_b32 s65, s2, 14
    s_add_u32 s65, s65, 28311552
    buffer_store_dwordx4 v[4:7], v1, s[24:27], s65 offen offset:0 sc1
    buffer_store_dwordx4 v[4:7], v1, s[24:27], s65 offen offset:1024 sc1
    buffer_store_dwordx4 v[4:7], v1, s[24:27], s65 offen offset:2048 sc1
    buffer_store_dwordx4 v[4:7], v1, s[24:27], s65 offen offset:3072 sc1
    s_lshl_b32 s65, s2, 14
    s_add_u32 s65, s65, 28315648
    buffer_store_dwordx4 v[4:7], v1, s[24:27], s65 offen offset:0 sc1
    buffer_store_dwordx4 v[4:7], v1, s[24:27], s65 offen offset:1024 sc1
    buffer_store_dwordx4 v[4:7], v1, s[24:27], s65 offen offset:2048 sc1
    buffer_store_dwordx4 v[4:7], v1, s[24:27], s65 offen offset:3072 sc1
    s_waitcnt vmcnt(15)
    s_barrier
    s_lshl_b32 s65, s2, 14
    s_add_u32 s65, s65, 28319744
    buffer_store_dwordx4 v[4:7], v1, s[24:27], s65 offen offset:0 sc1
    buffer_store_dwordx4 v[4:7], v1, s[24:27], s65 offen offset:1024 sc1
    buffer_store_dwordx4 v[4:7], v1, s[24:27], s65 offen offset:2048 sc1
    buffer_store_dwordx4 v[4:7], v1, s[24:27], s65 offen offset:3072 sc1
    s_lshl_b32 s65, s2, 14
    s_add_u32 s65, s65, 28323840
    buffer_store_dwordx4 v[4:7], v1, s[24:27], s65 offen offset:0 sc1
    buffer_store_dwordx4 v[4:7], v1, s[24:27], s65 offen offset:1024 sc1
    buffer_store_dwordx4 v[4:7], v1, s[24:27], s65 offen offset:2048 sc1
    buffer_store_dwordx4 v[4:7], v1, s[24:27], s65 offen offset:3072 sc1
    s_waitcnt vmcnt(18)
    s_barrier
    s_waitcnt vmcnt(0)
    s_mov_b32 s69, 30000
F_ini:
    v_cmp_gt_u32 vcc, 16, v153
    s_nop 4
    s_cbranch_vccz F_inid
    buffer_load_dword v153, v152, s[52:55], 0 offen sc1
    s_waitcnt vmcnt(0)
    s_sub_u32 s69, s69, 1
    s_cmp_lg_u32 s69, 0
    s_cbranch_scc1 F_ini
F_inid:
    s_waitcnt lgkmcnt(0)
    s_setprio 3
    s_barrier
    s_branch F_h2x
F_hm3:
    v_lshrrev_b32 v2, 3, v0
    v_lshrrev_b32 v3, 2, v2
    v_xor_b32 v4, 0, v3
    v_lshlrev_b32 v4, 2, v4
    v_lshl_add_u32 v4, v3, 3, v4
    v_and_b32 v5, 3, v2
    v_add3_u32 v4, v4, v5, 0
    v_lshlrev_b32 v184, 11, v4
    v_lshrrev_b32 v4, 1, v2
    v_add_u32 v4, 0, v4
    v_and_b32 v5, 7, v0
    v_xor_b32 v4, v4, v5
    v_lshl_add_u32 v184, v4, 4, v184
    v_xor_b32 v4, 0, v3
    v_lshlrev_b32 v4, 2, v4
    v_lshl_add_u32 v4, v3, 3, v4
    v_and_b32 v5, 3, v2
    v_add3_u32 v4, v4, v5, 16
    v_lshlrev_b32 v185, 11, v4
    v_lshrrev_b32 v4, 1, v2
    v_add_u32 v4, 4, v4
    v_and_b32 v5, 7, v0
    v_xor_b32 v4, v4, v5
    v_lshl_add_u32 v185, v4, 4, v185
    v_xor_b32 v4, 1, v3
    v_lshlrev_b32 v4, 2, v4
    v_lshl_add_u32 v4, v3, 3, v4
    v_and_b32 v5, 3, v2
    v_add3_u32 v4, v4, v5, 0
    v_lshlrev_b32 v186, 11, v4
    v_lshrrev_b32 v4, 1, v2
    v_add_u32 v4, 0, v4
    v_and_b32 v5, 7, v0
    v_xor_b32 v4, v4, v5
    v_lshl_add_u32 v186, v4, 4, v186
    v_xor_b32 v4, 1, v3
    v_lshlrev_b32 v4, 2, v4
    v_lshl_add_u32 v4, v3, 3, v4
    v_and_b32 v5, 3, v2
    v_add3_u32 v4, v4, v5, 16
    v_lshlrev_b32 v187, 11, v4
    v_lshrrev_b32 v4, 1, v2
    v_add_u32 v4, 4, v4
    v_and_b32 v5, 7, v0
    v_xor_b32 v4, v4, v5
    v_lshl_add_u32 v187, v4, 4, v187
    s_mov_b32 s59, 49152
    s_mov_b32 s60, 0
    s_mov_b32 s61, 0
    s_lshl_b32 s62, s3, 18
    s_mov_b32 s58, 2
F_pp3:
    s_add_u32 s64, s62, 0
    s_add_u32 m0, s60, 2048
    s_nop 0
    buffer_load_dwordx4 v186, s[8:11], s64 offen lds
    s_add_u32 s64, s62, 0
    s_add_u32 m0, s60, 3072
    s_nop 0
    buffer_load_dwordx4 v187, s[8:11], s64 offen lds
    s_add_u32 s64, s62, 65536
    s_add_u32 m0, s60, 4096
    s_nop 0
    buffer_load_dwordx4 v184, s[8:11], s64 offen lds
    s_add_u32 s64, s62, 65536
    s_add_u32 m0, s60, 5120
    s_nop 0
    buffer_load_dwordx4 v185, s[8:11], s64 offen lds
    s_add_u32 s64, s62, 65536
    s_add_u32 m0, s60, 6144
    s_nop 0
    buffer_load_dwordx4 v186, s[8:11], s64 offen lds
    s_add_u32 s64, s62, 65536
    s_add_u32 m0, s60, 7168
    s_nop 0
    buffer_load_dwordx4 v187, s[8:11], s64 offen lds
    s_add_u32 s64, s62, 131072
    s_add_u32 m0, s60, 10240
    s_nop 0
    buffer_load_dwordx4 v186, s[8:11], s64 offen lds
    s_add_u32 s64, s62, 131072
    s_add_u32 m0, s60, 11264
    s_nop 0
    buffer_load_dwordx4 v187, s[8:11], s64 offen lds
    s_add_u32 s64, s62, 196608
    s_add_u32 m0, s60, 12288
    s_nop 0
    buffer_load_dwordx4 v184, s[8:11], s64 offen lds
    s_add_u32 s64, s62, 196608
    s_add_u32 m0, s60, 13312
    s_nop 0
    buffer_load_dwordx4 v185, s[8:11], s64 offen lds
    s_add_u32 s64, s62, 196608
    s_add_u32 m0, s60, 14336
    s_nop 0
    buffer_load_dwordx4 v186, s[8:11], s64 offen lds
    s_add_u32 s64, s62, 196608
    s_add_u32 m0, s60, 15360
    s_nop 0
    buffer_load_dwordx4 v187, s[8:11], s64 offen lds
    s_add_u32 s60, s60, 16384
    s_cmp_eq_u32 s60, 49152
    s_cselect_b32 s60, 0, s60
    s_add_u32 s62, s62, 128
    s_sub_u32 s58, s58, 1
    s_cmp_lg_u32 s58, 0
    s_cbranch_scc1 F_pp3
    v_and_b32 v2, 15, v0
    v_lshrrev_b32 v3, 1, v2
    v_lshrrev_b32 v192, 4, v0
    v_xor_b32 v192, v192, v3
    v_lshlrev_b32 v192, 4, v192
    v_lshl_add_u32 v192, v2, 7, v192
    s_lshr_b32 s64, s4, 2
    s_lshl_b32 s64, s64, 12
    v_add_u32 v192, s64, v192
    v_lshlrev_b32 v194, 3, v0
    v_add_u32 v194, 18432, v194
    v_mov_b32 v144, 0
    v_mov_b32 v145, 0
    v_mov_b32 v146, 0
    v_mov_b32 v147, 0
    v_mov_b32 v148, 0
    v_mov_b32 v149, 0
    v_mov_b32 v150, 0
    v_mov_b32 v151, 0
    s_mov_b32 s56, 49152
    s_mov_b32 s57, 0
    s_bfe_u32 s63, s4, 0x10001
    s_and_b32 s65, s4, 1
    s_lshl_b32 s65, s65, 3
    s_cmp_eq_u32 s63, 0
    s_cselect_b32 s7, 0x3e8293ee, 1.0
    s_cbranch_scc0 F_vst
    v_bfe_u32 v2, v0, 2, 2
    v_and_b32 v3, 1, v2
    v_lshlrev_b32 v3, 2, v3
    v_lshl_add_u32 v3, v2, 3, v3
    v_and_b32 v2, 3, v0
    v_add_u32 v3, v3, v2
    v_and_b32 v2, 32, v0
    v_add_u32 v3, v3, v2
    v_lshlrev_b32 v3, 4, v3
    v_bfe_u32 v2, v0, 4, 1
    v_lshl_add_u32 v3, v2, 10, v3
    v_add_u32 v154, s65, v3
    v_xor_b32 v155, 64, v154
    s_branch F_kst
F_vst:
    v_bfe_u32 v2, v0, 3, 1
    v_and_b32 v3, 7, v0
    v_lshl_add_u32 v3, v2, 4, v3
    v_add_u32 v3, s65, v3
    v_bfe_u32 v2, v0, 4, 1
    v_lshl_add_u32 v3, v2, 5, v3
    v_lshlrev_b32 v3, 4, v3
    v_lshl_add_u32 v3, v2, 3, v3
    v_lshrrev_b32 v2, 5, v0
    v_lshl_add_u32 v3, v2, 10, v3
    v_add_u32 v154, 2048, v3
    v_xor_b32 v155, 8, v154
F_kst:
    s_setprio 3
    s_mov_b32 s58, 14
F_pl3:
    s_waitcnt vmcnt(12)
    s_barrier
    v_add_u32 v191, s57, v192
    s_add_u32 s57, s57, 16384
    s_cmp_eq_u32 s57, 49152
    s_cselect_b32 s57, 0, s57
    v_add_u32 v193, s56, v194
    s_add_u32 s56, s56, 19456
    s_cmp_eq_u32 s56, 146432
    s_cselect_b32 s56, 49152, s56
    ds_read_b128 v[132:135], v191
    ds_read_b128 v[136:139], v191 offset:2048
    ds_read_b64_tr_b16 v[140:141], v193
    ds_read_b64_tr_b16 v[142:143], v193 offset:512
    s_add_u32 s64, s62, 0
    s_add_u32 m0, s60, 2048
    s_nop 0
    buffer_load_dwordx4 v186, s[8:11], s64 offen lds
    s_add_u32 s64, s62, 0
    s_add_u32 m0, s60, 3072
    s_nop 0
    buffer_load_dwordx4 v187, s[8:11], s64 offen lds
    s_add_u32 s64, s62, 65536
    s_add_u32 m0, s60, 4096
    s_nop 0
    buffer_load_dwordx4 v184, s[8:11], s64 offen lds
    s_add_u32 s64, s62, 65536
    s_add_u32 m0, s60, 5120
    s_nop 0
    buffer_load_dwordx4 v185, s[8:11], s64 offen lds
    s_add_u32 s64, s62, 65536
    s_add_u32 m0, s60, 6144
    s_nop 0
    buffer_load_dwordx4 v186, s[8:11], s64 offen lds
    s_add_u32 s64, s62, 65536
    s_add_u32 m0, s60, 7168
    s_nop 0
    buffer_load_dwordx4 v187, s[8:11], s64 offen lds
    s_waitcnt lgkmcnt(0)
    s_cmp_eq_u32 s63, 0
    s_cbranch_scc0 F_kv6
    v_mfma_f32_16x16x32_bf16 v[144:147], v[140:143], v[132:135], v[144:147]
    v_mfma_f32_16x16x32_bf16 v[148:151], v[140:143], v[136:139], v[148:151]
    s_branch F_ke6
F_kv6:
    v_mfma_f32_16x16x32_bf16 v[144:147], v[132:135], v[140:143], v[144:147]
    v_mfma_f32_16x16x32_bf16 v[148:151], v[136:139], v[140:143], v[148:151]
F_ke6:
    s_waitcnt vmcnt(18)
    s_barrier
    v_xor_b32 v191, 64, v191
    v_add_u32 v193, s56, v194
    s_add_u32 s56, s56, 19456
    s_cmp_eq_u32 s56, 146432
    s_cselect_b32 s56, 49152, s56
    ds_read_b128 v[132:135], v191
    ds_read_b128 v[136:139], v191 offset:2048
    ds_read_b64_tr_b16 v[140:141], v193
    ds_read_b64_tr_b16 v[142:143], v193 offset:512
    s_add_u32 s64, s62, 131072
    s_add_u32 m0, s60, 10240
    s_nop 0
    buffer_load_dwordx4 v186, s[8:11], s64 offen lds
    s_add_u32 s64, s62, 131072
    s_add_u32 m0, s60, 11264
    s_nop 0
    buffer_load_dwordx4 v187, s[8:11], s64 offen lds
    s_add_u32 s64, s62, 196608
    s_add_u32 m0, s60, 12288
    s_nop 0
    buffer_load_dwordx4 v184, s[8:11], s64 offen lds
    s_add_u32 s64, s62, 196608
    s_add_u32 m0, s60, 13312
    s_nop 0
    buffer_load_dwordx4 v185, s[8:11], s64 offen lds
    s_add_u32 s64, s62, 196608
    s_add_u32 m0, s60, 14336
    s_nop 0
    buffer_load_dwordx4 v186, s[8:11], s64 offen lds
    s_add_u32 s64, s62, 196608
    s_add_u32 m0, s60, 15360
    s_nop 0
    buffer_load_dwordx4 v187, s[8:11], s64 offen lds
    s_add_u32 s60, s60, 16384
    s_cmp_eq_u32 s60, 49152
    s_cselect_b32 s60, 0, s60
    s_add_u32 s62, s62, 128
    s_waitcnt lgkmcnt(0)
    s_cmp_eq_u32 s63, 0
    s_cbranch_scc0 F_kv7
    v_mfma_f32_16x16x32_bf16 v[144:147], v[140:143], v[132:135], v[144:147]
    v_mfma_f32_16x16x32_bf16 v[148:151], v[140:143], v[136:139], v[148:151]
    s_branch F_ke7
F_kv7:
    v_mfma_f32_16x16x32_bf16 v[144:147], v[132:135], v[140:143], v[144:147]
    v_mfma_f32_16x16x32_bf16 v[148:151], v[136:139], v[140:143], v[148:151]
F_ke7:
    s_sub_u32 s58, s58, 1
    s_cmp_lg_u32 s58, 0
    s_cbranch_scc1 F_pl3
    s_waitcnt vmcnt(12)
    s_barrier
    v_add_u32 v191, s57, v192
    s_add_u32 s57, s57, 16384
    s_cmp_eq_u32 s57, 49152
    s_cselect_b32 s57, 0, s57
    v_add_u32 v193, s56, v194
    s_add_u32 s56, s56, 19456
    s_cmp_eq_u32 s56, 146432
    s_cselect_b32 s56, 49152, s56
    ds_read_b128 v[132:135], v191
    ds_read_b128 v[136:139], v191 offset:2048
    ds_read_b64_tr_b16 v[140:141], v193
    ds_read_b64_tr_b16 v[142:143], v193 offset:512
    s_waitcnt lgkmcnt(0)
    s_cmp_eq_u32 s63, 0
    s_cbranch_scc0 F_kv8
    v_mfma_f32_16x16x32_bf16 v[144:147], v[140:143], v[132:135], v[144:147]
    v_mfma_f32_16x16x32_bf16 v[148:151], v[140:143], v[136:139], v[148:151]
    s_branch F_ke8
F_kv8:
    v_mfma_f32_16x16x32_bf16 v[144:147], v[132:135], v[140:143], v[144:147]
    v_mfma_f32_16x16x32_bf16 v[148:151], v[136:139], v[140:143], v[148:151]
F_ke8:
    s_waitcnt vmcnt(12)
    s_barrier
    v_xor_b32 v191, 64, v191
    v_add_u32 v193, s56, v194
    s_add_u32 s56, s56, 19456
    s_cmp_eq_u32 s56, 146432
    s_cselect_b32 s56, 49152, s56
    ds_read_b128 v[132:135], v191
    ds_read_b128 v[136:139], v191 offset:2048
    ds_read_b64_tr_b16 v[140:141], v193
    ds_read_b64_tr_b16 v[142:143], v193 offset:512
    s_waitcnt lgkmcnt(0)
    s_cmp_eq_u32 s63, 0
    s_cbranch_scc0 F_kv9
    v_mfma_f32_16x16x32_bf16 v[144:147], v[140:143], v[132:135], v[144:147]
    v_mfma_f32_16x16x32_bf16 v[148:151], v[140:143], v[136:139], v[148:151]
    s_branch F_ke9
F_kv9:
    v_mfma_f32_16x16x32_bf16 v[144:147], v[132:135], v[140:143], v[144:147]
    v_mfma_f32_16x16x32_bf16 v[148:151], v[136:139], v[140:143], v[148:151]
F_ke9:
    s_waitcnt vmcnt(0)
    s_barrier
    v_add_u32 v191, s57, v192
    s_add_u32 s57, s57, 16384
    s_cmp_eq_u32 s57, 49152
    s_cselect_b32 s57, 0, s57
    v_add_u32 v193, s56, v194
    s_add_u32 s56, s56, 19456
    s_cmp_eq_u32 s56, 146432
    s_cselect_b32 s56, 49152, s56
    ds_read_b128 v[132:135], v191
    ds_read_b128 v[136:139], v191 offset:2048
    ds_read_b64_tr_b16 v[140:141], v193
    ds_read_b64_tr_b16 v[142:143], v193 offset:512
    s_waitcnt lgkmcnt(0)
    s_cmp_eq_u32 s63, 0
    s_cbranch_scc0 F_kv10
    v_mfma_f32_16x16x32_bf16 v[144:147], v[140:143], v[132:135], v[144:147]
    v_mfma_f32_16x16x32_bf16 v[148:151], v[140:143], v[136:139], v[148:151]
    s_branch F_ke10
F_kv10:
    v_mfma_f32_16x16x32_bf16 v[144:147], v[132:135], v[140:143], v[144:147]
    v_mfma_f32_16x16x32_bf16 v[148:151], v[136:139], v[140:143], v[148:151]
F_ke10:
    s_waitcnt vmcnt(0)
    s_barrier
    v_xor_b32 v191, 64, v191
    v_add_u32 v193, s56, v194
    s_add_u32 s56, s56, 19456
    s_cmp_eq_u32 s56, 146432
    s_cselect_b32 s56, 49152, s56
    ds_read_b128 v[132:135], v191
    ds_read_b128 v[136:139], v191 offset:2048
    ds_read_b64_tr_b16 v[140:141], v193
    ds_read_b64_tr_b16 v[142:143], v193 offset:512
    s_waitcnt lgkmcnt(0)
    s_cmp_eq_u32 s63, 0
    s_cbranch_scc0 F_kv11
    v_mfma_f32_16x16x32_bf16 v[144:147], v[140:143], v[132:135], v[144:147]
    v_mfma_f32_16x16x32_bf16 v[148:151], v[140:143], v[136:139], v[148:151]
    s_branch F_ke11
F_kv11:
    v_mfma_f32_16x16x32_bf16 v[144:147], v[132:135], v[140:143], v[144:147]
    v_mfma_f32_16x16x32_bf16 v[148:151], v[136:139], v[140:143], v[148:151]
F_ke11:
    s_and_b32 s64, s2, 7
    s_lshl_b32 s64, s64, 3
    s_lshr_b32 s65, s2, 5
    s_add_u32 s64, s64, s65
    s_lshl_b32 s64, s64, 12
    s_add_u32 s64, s64, 4194304
    v_mul_f32 v144, s7, v144
    v_mul_f32 v145, s7, v145
    v_mul_f32 v146, s7, v146
    v_mul_f32 v147, s7, v147
    v_mul_f32 v148, s7, v148
    v_mul_f32 v149, s7, v149
    v_mul_f32 v150, s7, v150
    v_mul_f32 v151, s7, v151
    v_cvt_pk_bf16_f32 v4, v144, v145
    v_cvt_pk_bf16_f32 v5, v146, v147
    v_cvt_pk_bf16_f32 v6, v148, v149
    v_cvt_pk_bf16_f32 v7, v150, v151
    buffer_store_dwordx2 v[4:5], v154, s[24:27], s64 offen sc1
    buffer_store_dwordx2 v[6:7], v155, s[24:27], s64 offen sc1
    s_and_b32 s64, s2, 7
    s_lshl_b32 s64, s64, 5
    s_lshr_b32 s65, s2, 3
    s_add_u32 s64, s64, s65
    s_lshl_b32 s64, s64, 7
    s_add_u32 s64, s64, 4726784
    s_setprio 3
    s_barrier
    s_waitcnt vmcnt(0)
    v_mov_b32 v2, 0
    buffer_store_dword v2, v2, s[24:27], s64 offen sc1
F_h2x:
    s_and_b32 s64, s2, 7
    s_lshl_b32 s62, s6, 10
    s_add_u32 s62, s62, 4726784
    s_lshl_b32 s61, s64, 15
    s_lshl_b32 s7, s6, 13
    s_add_u32 s59, s7, 94208
    s_add_u32 s57, s7, 159744
    s_add_u32 s60, s7, 94208
    s_add_u32 s7, s7, 4194304
    s_mov_b64 s[70:71], -1
    s_mov_b32 s69, 30000
F_poll12:
    buffer_load_dword v2, v212, s[24:27], s62 offen sc1
    s_waitcnt vmcnt(0)
    v_cmp_eq_u32 vcc, -1, v2
    s_nop 4
    s_cbranch_vccz F_done12
    s_sleep 8
    s_sub_u32 s69, s69, 1
    s_cmp_lg_u32 s69, 0
    s_cbranch_scc1 F_poll12
F_done12:
    s_lshl_b32 s70, s70, 8
    s_bfe_u32 s64, s70, 524288
    s_cbranch_scc0 F_rdy13
    s_mov_b32 s65, 30000
F_look13:
    buffer_load_dword v2, v213, s[24:27], s62 offen sc1
    s_waitcnt vmcnt(0)
    v_cmp_eq_u32 s[70:71], -1, v2
    s_nop 4
    s_bfe_u32 s64, s70, 524288
    s_cbranch_scc0 F_rdy13
    s_sleep 4
    s_sub_u32 s65, s65, 1
    s_cmp_lg_u32 s65, 0
    s_cbranch_scc1 F_look13
F_rdy13:
    s_add_u32 s65, s61, s7
    s_add_u32 s64, s65, 4096
    s_add_u32 m0, s59, 0
    s_nop 0
    buffer_load_dwordx4 v1, s[24:27], s65 offen offset:0 sc1 lds
    buffer_load_dwordx4 v1, s[24:27], s65 offen offset:1024 sc1 lds
    buffer_load_dwordx4 v1, s[24:27], s65 offen offset:2048 sc1 lds
    buffer_load_dwordx4 v1, s[24:27], s65 offen offset:3072 sc1 lds
    s_add_u32 m0, s59, 4096
    s_nop 0
    buffer_load_dwordx4 v1, s[24:27], s64 offen offset:0 sc1 lds
    buffer_load_dwordx4 v1, s[24:27], s64 offen offset:1024 sc1 lds
    buffer_load_dwordx4 v1, s[24:27], s64 offen offset:2048 sc1 lds
    buffer_load_dwordx4 v1, s[24:27], s64 offen offset:3072 sc1 lds
    s_add_u32 s61, s61, 32768
    s_and_b32 s61, s61, 262143
    s_add_u32 s59, s59, 32768
    s_cmp_eq_u32 s59, s57
    s_cselect_b32 s59, s60, s59
    v_mov_b32 v4, 0
    v_mov_b32 v5, 0
    v_mov_b32 v6, 0
    v_mov_b32 v7, 0
    s_nop 1
    v_mfma_f32_32x32x16_bf16 v[148:163], v[4:7], v[4:7], 0
    v_mfma_f32_32x32x16_bf16 v[164:179], v[4:7], v[4:7], 0
    v_mfma_f32_32x32x16_bf16 v[180:195], v[4:7], v[4:7], 0
    v_mfma_f32_16x16x32_bf16 v[196:199], v[4:7], v[4:7], 0
    v_mfma_f32_16x16x32_bf16 v[200:203], v[4:7], v[4:7], 0
    s_waitcnt vmcnt(0)
    s_barrier
    ds_read_b128 v[228:231], v214 offset:0
    ds_read_b128 v[28:31], v214 offset:28672
    ds_read_b128 v[232:235], v214 offset:1024
    ds_read_b128 v[32:35], v214 offset:29696
    ds_read_b128 v[236:239], v214 offset:2048
    ds_read_b128 v[36:39], v214 offset:30720
    ds_read_b128 v[240:243], v214 offset:3072
    ds_read_b128 v[40:43], v214 offset:31744
    ds_read_b128 v[244:247], v214 offset:4096
    ds_read_b128 v[44:47], v214 offset:32768
    ds_read_b128 v[248:251], v214 offset:5120
    ds_read_b128 v[48:51], v214 offset:33792
    ds_read_b128 v[252:255], v214 offset:6144
    ds_read_b128 v[52:55], v214 offset:34816
    s_bfe_u32 s64, s70, 524296
    s_cbranch_scc0 F_rdy14
    s_mov_b32 s65, 30000
F_look14:
    buffer_load_dword v2, v213, s[24:27], s62 offen sc1
    s_waitcnt vmcnt(0)
    v_cmp_eq_u32 s[70:71], -1, v2
    s_nop 4
    s_bfe_u32 s64, s70, 524296
    s_cbranch_scc0 F_rdy14
    s_sleep 4
    s_sub_u32 s65, s65, 1
    s_cmp_lg_u32 s65, 0
    s_cbranch_scc1 F_look14
F_rdy14:
    s_add_u32 s65, s61, s7
    s_add_u32 s64, s65, 4096
    s_add_u32 m0, s59, 0
    s_nop 0
    buffer_load_dwordx4 v1, s[24:27], s65 offen offset:0 sc1 lds
    buffer_load_dwordx4 v1, s[24:27], s65 offen offset:1024 sc1 lds
    buffer_load_dwordx4 v1, s[24:27], s65 offen offset:2048 sc1 lds
    buffer_load_dwordx4 v1, s[24:27], s65 offen offset:3072 sc1 lds
    s_add_u32 m0, s59, 4096
    s_nop 0
    buffer_load_dwordx4 v1, s[24:27], s64 offen offset:0 sc1 lds
    buffer_load_dwordx4 v1, s[24:27], s64 offen offset:1024 sc1 lds
    buffer_load_dwordx4 v1, s[24:27], s64 offen offset:2048 sc1 lds
    buffer_load_dwordx4 v1, s[24:27], s64 offen offset:3072 sc1 lds
    s_add_u32 s61, s61, 32768
    s_and_b32 s61, s61, 262143
    s_add_u32 s59, s59, 32768
    s_cmp_eq_u32 s59, s57
    s_cselect_b32 s59, s60, s59
    s_waitcnt lgkmcnt(0)
    s_lshl_b32 s64, s2, 2
    s_add_u32 s64, s64, s6
    s_lshl_b32 s64, s64, 13
    s_add_u32 s64, s64, 33554432
    s_bitcmp1_b32 s4, 0
    s_cbranch_scc1 F_xso
    buffer_store_dwordx4 v[28:31], v223, s[24:27], s64 offen offset:0 sc1
    buffer_store_dwordx4 v[32:35], v223, s[24:27], s64 offen offset:128 sc1
    buffer_store_dwordx4 v[36:39], v223, s[24:27], s64 offen offset:256 sc1
    buffer_store_dwordx4 v[40:43], v223, s[24:27], s64 offen offset:512 sc1
    buffer_store_dwordx4 v[44:47], v223, s[24:27], s64 offen offset:640 sc1
    buffer_store_dwordx4 v[48:51], v223, s[24:27], s64 offen offset:768 sc1
    buffer_store_dwordx4 v[52:55], v223, s[24:27], s64 offen offset:896 sc1
    s_branch F_xse
F_xso:
    buffer_store_dwordx4 v[228:231], v223, s[24:27], s64 offen offset:0 sc1
    buffer_store_dwordx4 v[232:235], v223, s[24:27], s64 offen offset:128 sc1
    buffer_store_dwordx4 v[236:239], v223, s[24:27], s64 offen offset:256 sc1
    buffer_store_dwordx4 v[240:243], v223, s[24:27], s64 offen offset:512 sc1
    buffer_store_dwordx4 v[244:247], v223, s[24:27], s64 offen offset:640 sc1
    buffer_store_dwordx4 v[248:251], v223, s[24:27], s64 offen offset:768 sc1
    buffer_store_dwordx4 v[252:255], v223, s[24:27], s64 offen offset:896 sc1
F_xse:
    s_waitcnt vmcnt(7)
    s_barrier
    s_lshl_b32 s64, s3, 4
    s_add_u32 s64, s64, s4
    s_lshl_b32 s64, s64, 5
    s_and_b32 s65, s5, 3
    s_add_u32 s64, s64, s65
    s_lshl_b32 s64, s64, 2
    s_add_u32 s64, s64, 4825088
    s_waitcnt vmcnt(0)
    v_mov_b32 v8, 0
    buffer_store_dword v8, v8, s[24:27], s64 offen sc1
    s_xor_b32 s73, s64, 128
    s_bfe_u32 s64, s70, 524304
    s_cbranch_scc0 F_rdy15
    s_mov_b32 s65, 30000
F_look15:
    buffer_load_dword v2, v213, s[24:27], s62 offen sc1
    s_waitcnt vmcnt(0)
    v_cmp_eq_u32 s[70:71], -1, v2
    s_nop 4
    s_bfe_u32 s64, s70, 524304
    s_cbranch_scc0 F_rdy15
    s_sleep 4
    s_sub_u32 s65, s65, 1
    s_cmp_lg_u32 s65, 0
    s_cbranch_scc1 F_look15
F_rdy15:
    s_add_u32 s65, s61, s7
    s_add_u32 s64, s65, 4096
    s_add_u32 m0, s59, 0
    s_nop 0
    buffer_load_dwordx4 v1, s[24:27], s65 offen offset:0 sc1 lds
    buffer_load_dwordx4 v1, s[24:27], s65 offen offset:1024 sc1 lds
    buffer_load_dwordx4 v1, s[24:27], s65 offen offset:2048 sc1 lds
    buffer_load_dwordx4 v1, s[24:27], s65 offen offset:3072 sc1 lds
    s_add_u32 m0, s59, 4096
    s_nop 0
    buffer_load_dwordx4 v1, s[24:27], s64 offen offset:0 sc1 lds
    buffer_load_dwordx4 v1, s[24:27], s64 offen offset:1024 sc1 lds
    buffer_load_dwordx4 v1, s[24:27], s64 offen offset:2048 sc1 lds
    buffer_load_dwordx4 v1, s[24:27], s64 offen offset:3072 sc1 lds
    s_add_u32 s61, s61, 32768
    s_and_b32 s61, s61, 262143
    s_add_u32 s59, s59, 32768
    s_cmp_eq_u32 s59, s57
    s_cselect_b32 s59, s60, s59
    s_mov_b32 s69, 30000
F_poll16:
    buffer_load_dword v4, v8, s[24:27], s73 offen sc1
    s_waitcnt vmcnt(0)
    v_cmp_eq_u32 vcc, -1, v4
    s_nop 4
    s_cbranch_vccz F_done16
    s_sleep 4
    s_sub_u32 s69, s69, 1
    s_cmp_lg_u32 s69, 0
    s_cbranch_scc1 F_poll16
F_done16:
    s_xor_b32 s66, s2, 8
    s_lshl_b32 s64, s66, 2
    s_add_u32 s64, s64, s6
    s_lshl_b32 s64, s64, 13
    s_add_u32 s64, s64, 33554432
    s_bitcmp1_b32 s4, 0
    s_cbranch_scc1 F_xlo
    buffer_load_dwordx4 v[28:31], v223, s[24:27], s64 offen offset:0 sc1
    buffer_load_dwordx4 v[32:35], v223, s[24:27], s64 offen offset:128 sc1
    buffer_load_dwordx4 v[36:39], v223, s[24:27], s64 offen offset:256 sc1
    buffer_load_dwordx4 v[40:43], v223, s[24:27], s64 offen offset:512 sc1
    buffer_load_dwordx4 v[44:47], v223, s[24:27], s64 offen offset:640 sc1
    buffer_load_dwordx4 v[48:51], v223, s[24:27], s64 offen offset:768 sc1
    buffer_load_dwordx4 v[52:55], v223, s[24:27], s64 offen offset:896 sc1
    s_branch F_xle
F_xlo:
    buffer_load_dwordx4 v[228:231], v223, s[24:27], s64 offen offset:0 sc1
    buffer_load_dwordx4 v[232:235], v223, s[24:27], s64 offen offset:128 sc1
    buffer_load_dwordx4 v[236:239], v223, s[24:27], s64 offen offset:256 sc1
    buffer_load_dwordx4 v[240:243], v223, s[24:27], s64 offen offset:512 sc1
    buffer_load_dwordx4 v[244:247], v223, s[24:27], s64 offen offset:640 sc1
    buffer_load_dwordx4 v[248:251], v223, s[24:27], s64 offen offset:768 sc1
    buffer_load_dwordx4 v[252:255], v223, s[24:27], s64 offen offset:896 sc1
F_xle:
    s_barrier
    s_bfe_u32 s64, s70, 524312
    s_cbranch_scc0 F_rdy17
    s_mov_b32 s65, 30000
F_look17:
    buffer_load_dword v2, v213, s[24:27], s62 offen sc1
    s_waitcnt vmcnt(0)
    v_cmp_eq_u32 s[70:71], -1, v2
    s_nop 4
    s_bfe_u32 s64, s70, 524312
    s_cbranch_scc0 F_rdy17
    s_sleep 4
    s_sub_u32 s65, s65, 1
    s_cmp_lg_u32 s65, 0
    s_cbranch_scc1 F_look17
F_rdy17:
    s_add_u32 s65, s61, s7
    s_add_u32 s64, s65, 4096
    s_add_u32 m0, s59, 0
    s_nop 0
    buffer_load_dwordx4 v1, s[24:27], s65 offen offset:0 sc1 lds
    buffer_load_dwordx4 v1, s[24:27], s65 offen offset:1024 sc1 lds
    buffer_load_dwordx4 v1, s[24:27], s65 offen offset:2048 sc1 lds
    buffer_load_dwordx4 v1, s[24:27], s65 offen offset:3072 sc1 lds
    s_add_u32 m0, s59, 4096
    s_nop 0
    buffer_load_dwordx4 v1, s[24:27], s64 offen offset:0 sc1 lds
    buffer_load_dwordx4 v1, s[24:27], s64 offen offset:1024 sc1 lds
    buffer_load_dwordx4 v1, s[24:27], s64 offen offset:2048 sc1 lds
    buffer_load_dwordx4 v1, s[24:27], s64 offen offset:3072 sc1 lds
    s_add_u32 s61, s61, 32768
    s_and_b32 s61, s61, 262143
    s_add_u32 s59, s59, 32768
    s_cmp_eq_u32 s59, s57
    s_cselect_b32 s59, s60, s59
    s_lshl_b32 s66, s3, 14
    s_lshl_b32 s67, s6, 8
    s_add_u32 s66, s66, s67
    s_add_u32 s66, s66, 4456448
    s_mov_b32 s69, 30000
F_poll18:
    buffer_load_dwordx4 v[12:15], v215, s[24:27], s66 offen offset:0 sc1
    buffer_load_dwordx4 v[16:19], v215, s[24:27], s66 offen offset:1024 sc1
    buffer_load_dwordx4 v[20:23], v215, s[24:27], s66 offen offset:2048 sc1
    buffer_load_dwordx4 v[24:27], v215, s[24:27], s66 offen offset:3072 sc1
    s_waitcnt vmcnt(0)
    v_max3_u32 v8, v12, v13, v14
    v_max3_u32 v8, v8, v15, v16
    v_max3_u32 v8, v8, v17, v18
    v_max3_u32 v8, v8, v19, v20
    v_max3_u32 v8, v8, v21, v22
    v_max3_u32 v8, v8, v23, v24
    v_max3_u32 v8, v8, v25, v26
    v_max_u32 v8, v8, v27
    v_cmp_eq_u32 vcc, -1, v8
    s_nop 4
    s_cbranch_vccz F_done18
    s_sleep 2
    s_sub_u32 s69, s69, 1
    s_cmp_lg_u32 s69, 0
    s_cbranch_scc1 F_poll18
F_done18:
    v_add_f32 v12, v12, v16
    v_add_f32 v13, v13, v17
    v_add_f32 v14, v14, v18
    v_add_f32 v15, v15, v19
    v_add_f32 v12, v12, v20
    v_add_f32 v13, v13, v21
    v_add_f32 v14, v14, v22
    v_add_f32 v15, v15, v23
    v_add_f32 v12, v12, v24
    v_add_f32 v13, v13, v25
    v_add_f32 v14, v14, v26
    v_add_f32 v15, v15, v27
    v_mov_b32 v16, v12
    v_mov_b32 v17, v13
    v_mov_b32 v18, v14
    v_mov_b32 v19, v15
    v_permlane32_swap_b32 v12, v16
    v_permlane32_swap_b32 v13, v17
    v_permlane32_swap_b32 v14, v18
    v_permlane32_swap_b32 v15, v19
    v_add_f32 v12, v12, v16
    v_add_f32 v13, v13, v17
    v_add_f32 v14, v14, v18
    v_add_f32 v15, v15, v19
    v_mov_b32 v16, v12
    v_mov_b32 v17, v13
    v_mov_b32 v18, v14
    v_mov_b32 v19, v15
    v_permlane16_swap_b32 v12, v16
    v_permlane16_swap_b32 v13, v17
    v_permlane16_swap_b32 v14, v18
    v_permlane16_swap_b32 v15, v19
    v_add_f32 v12, v12, v16
    v_add_f32 v13, v13, v17
    v_add_f32 v14, v14, v18
    v_add_f32 v15, v15, v19
    v_mul_f32 v12, 0x3a124925, v12
    v_mul_f32 v13, 0x3a124925, v13
    v_mul_f32 v14, 0x3a124925, v14
    v_mul_f32 v15, 0x3a124925, v15
    v_fma_f32 v13, -v12, v12, v13
    v_fma_f32 v15, -v14, v14, v15
    v_max_f32 v13, 0, v13
    v_max_f32 v15, 0, v15
    v_add_f32 v13, 0x3727c5ac, v13
    v_add_f32 v15, 0x3727c5ac, v15
    v_rsq_f32 v13, v13
    v_rsq_f32 v15, v15
    v_mul_f32 v12, v12, v13
    v_mul_f32 v14, v14, v15
    s_waitcnt lgkmcnt(0)
    v_lshlrev_b32 v8, 16, v28
    v_and_b32 v9, 0xffff0000, v28
    v_fma_f32 v8, v8, v13, -v12
    v_fma_f32 v9, v9, v13, -v12
    v_cvt_pk_bf16_f32 v28, v8, v9
    v_lshlrev_b32 v8, 16, v29
    v_and_b32 v9, 0xffff0000, v29
    v_fma_f32 v8, v8, v13, -v12
    v_fma_f32 v9, v9, v13, -v12
    v_cvt_pk_bf16_f32 v29, v8, v9
    v_lshlrev_b32 v8, 16, v30
    v_and_b32 v9, 0xffff0000, v30
    v_fma_f32 v8, v8, v15, -v14
    v_fma_f32 v9, v9, v15, -v14
    v_cvt_pk_bf16_f32 v30, v8, v9
    v_lshlrev_b32 v8, 16, v31
    v_and_b32 v9, 0xffff0000, v31
    v_fma_f32 v8, v8, v15, -v14
    v_fma_f32 v9, v9, v15, -v14
    v_cvt_pk_bf16_f32 v31, v8, v9
    ds_write_b128 v216, v[28:31] offset:0
    ds_read_b64_tr_b16 v[28:29], v217 offset:0
    ds_read_b64_tr_b16 v[30:31], v218 offset:0
    v_lshlrev_b32 v8, 16, v32
    v_and_b32 v9, 0xffff0000, v32
    v_fma_f32 v8, v8, v13, -v12
    v_fma_f32 v9, v9, v13, -v12
    v_cvt_pk_bf16_f32 v32, v8, v9
    v_lshlrev_b32 v8, 16, v33
    v_and_b32 v9, 0xffff0000, v33
    v_fma_f32 v8, v8, v13, -v12
    v_fma_f32 v9, v9, v13, -v12
    v_cvt_pk_bf16_f32 v33, v8, v9
    v_lshlrev_b32 v8, 16, v34
    v_and_b32 v9, 0xffff0000, v34
    v_fma_f32 v8, v8, v15, -v14
    v_fma_f32 v9, v9, v15, -v14
    v_cvt_pk_bf16_f32 v34, v8, v9
    v_lshlrev_b32 v8, 16, v35
    v_and_b32 v9, 0xffff0000, v35
    v_fma_f32 v8, v8, v15, -v14
    v_fma_f32 v9, v9, v15, -v14
    v_cvt_pk_bf16_f32 v35, v8, v9
    ds_write_b128 v216, v[32:35] offset:1024
    ds_read_b64_tr_b16 v[32:33], v217 offset:1024
    ds_read_b64_tr_b16 v[34:35], v218 offset:1024
    v_lshlrev_b32 v8, 16, v36
    v_and_b32 v9, 0xffff0000, v36
    v_fma_f32 v8, v8, v13, -v12
    v_fma_f32 v9, v9, v13, -v12
    v_cvt_pk_bf16_f32 v36, v8, v9
    v_lshlrev_b32 v8, 16, v37
    v_and_b32 v9, 0xffff0000, v37
    v_fma_f32 v8, v8, v13, -v12
    v_fma_f32 v9, v9, v13, -v12
    v_cvt_pk_bf16_f32 v37, v8, v9
    v_lshlrev_b32 v8, 16, v38
    v_and_b32 v9, 0xffff0000, v38
    v_fma_f32 v8, v8, v15, -v14
    v_fma_f32 v9, v9, v15, -v14
    v_cvt_pk_bf16_f32 v38, v8, v9
    v_lshlrev_b32 v8, 16, v39
    v_and_b32 v9, 0xffff0000, v39
    v_fma_f32 v8, v8, v15, -v14
    v_fma_f32 v9, v9, v15, -v14
    v_cvt_pk_bf16_f32 v39, v8, v9
    ds_write_b128 v216, v[36:39] offset:2048
    ds_read_b64_tr_b16 v[36:37], v217 offset:2048
    ds_read_b64_tr_b16 v[38:39], v218 offset:2048
    v_lshlrev_b32 v8, 16, v40
    v_and_b32 v9, 0xffff0000, v40
    v_fma_f32 v8, v8, v13, -v12
    v_fma_f32 v9, v9, v13, -v12
    v_cvt_pk_bf16_f32 v40, v8, v9
    v_lshlrev_b32 v8, 16, v41
    v_and_b32 v9, 0xffff0000, v41
    v_fma_f32 v8, v8, v13, -v12
    v_fma_f32 v9, v9, v13, -v12
    v_cvt_pk_bf16_f32 v41, v8, v9
    v_lshlrev_b32 v8, 16, v42
    v_and_b32 v9, 0xffff0000, v42
    v_fma_f32 v8, v8, v15, -v14
    v_fma_f32 v9, v9, v15, -v14
    v_cvt_pk_bf16_f32 v42, v8, v9
    v_lshlrev_b32 v8, 16, v43
    v_and_b32 v9, 0xffff0000, v43
    v_fma_f32 v8, v8, v15, -v14
    v_fma_f32 v9, v9, v15, -v14
    v_cvt_pk_bf16_f32 v43, v8, v9
    ds_write_b128 v216, v[40:43] offset:3072
    ds_read_b64_tr_b16 v[40:41], v217 offset:3072
    ds_read_b64_tr_b16 v[42:43], v218 offset:3072
    v_lshlrev_b32 v8, 16, v44
    v_and_b32 v9, 0xffff0000, v44
    v_fma_f32 v8, v8, v13, -v12
    v_fma_f32 v9, v9, v13, -v12
    v_cvt_pk_bf16_f32 v44, v8, v9
    v_lshlrev_b32 v8, 16, v45
    v_and_b32 v9, 0xffff0000, v45
    v_fma_f32 v8, v8, v13, -v12
    v_fma_f32 v9, v9, v13, -v12
    v_cvt_pk_bf16_f32 v45, v8, v9
    v_lshlrev_b32 v8, 16, v46
    v_and_b32 v9, 0xffff0000, v46
    v_fma_f32 v8, v8, v15, -v14
    v_fma_f32 v9, v9, v15, -v14
    v_cvt_pk_bf16_f32 v46, v8, v9
    v_lshlrev_b32 v8, 16, v47
    v_and_b32 v9, 0xffff0000, v47
    v_fma_f32 v8, v8, v15, -v14
    v_fma_f32 v9, v9, v15, -v14
    v_cvt_pk_bf16_f32 v47, v8, v9
    ds_write_b128 v216, v[44:47] offset:4096
    ds_read_b64_tr_b16 v[44:45], v217 offset:4096
    ds_read_b64_tr_b16 v[46:47], v218 offset:4096
    v_lshlrev_b32 v8, 16, v48
    v_and_b32 v9, 0xffff0000, v48
    v_fma_f32 v8, v8, v13, -v12
    v_fma_f32 v9, v9, v13, -v12
    v_cvt_pk_bf16_f32 v48, v8, v9
    v_lshlrev_b32 v8, 16, v49
    v_and_b32 v9, 0xffff0000, v49
    v_fma_f32 v8, v8, v13, -v12
    v_fma_f32 v9, v9, v13, -v12
    v_cvt_pk_bf16_f32 v49, v8, v9
    v_lshlrev_b32 v8, 16, v50
    v_and_b32 v9, 0xffff0000, v50
    v_fma_f32 v8, v8, v15, -v14
    v_fma_f32 v9, v9, v15, -v14
    v_cvt_pk_bf16_f32 v50, v8, v9
    v_lshlrev_b32 v8, 16, v51
    v_and_b32 v9, 0xffff0000, v51
    v_fma_f32 v8, v8, v15, -v14
    v_fma_f32 v9, v9, v15, -v14
    v_cvt_pk_bf16_f32 v51, v8, v9
    ds_write_b128 v216, v[48:51] offset:5120
    ds_read_b64_tr_b16 v[48:49], v217 offset:5120
    ds_read_b64_tr_b16 v[50:51], v218 offset:5120
    v_lshlrev_b32 v8, 16, v52
    v_and_b32 v9, 0xffff0000, v52
    v_fma_f32 v8, v8, v13, -v12
    v_fma_f32 v9, v9, v13, -v12
    v_cvt_pk_bf16_f32 v52, v8, v9
    v_lshlrev_b32 v8, 16, v53
    v_and_b32 v9, 0xffff0000, v53
    v_fma_f32 v8, v8, v13, -v12
    v_fma_f32 v9, v9, v13, -v12
    v_cvt_pk_bf16_f32 v53, v8, v9
    v_lshlrev_b32 v8, 16, v54
    v_and_b32 v9, 0xffff0000, v54
    v_fma_f32 v8, v8, v15, -v14
    v_fma_f32 v9, v9, v15, -v14
    v_cvt_pk_bf16_f32 v54, v8, v9
    v_lshlrev_b32 v8, 16, v55
    v_and_b32 v9, 0xffff0000, v55
    v_fma_f32 v8, v8, v15, -v14
    v_fma_f32 v9, v9, v15, -v14
    v_cvt_pk_bf16_f32 v55, v8, v9
    ds_write_b128 v216, v[52:55] offset:6144
    ds_read_b64_tr_b16 v[52:53], v217 offset:6144
    ds_read_b64_tr_b16 v[54:55], v218 offset:6144
    s_barrier
    s_bfe_u32 s64, s71, 524288
    s_cbranch_scc0 F_rdy19
    s_mov_b32 s65, 30000
F_look19:
    buffer_load_dword v2, v213, s[24:27], s62 offen sc1
    s_waitcnt vmcnt(0)
    v_cmp_eq_u32 s[70:71], -1, v2
    s_nop 4
    s_bfe_u32 s64, s71, 524288
    s_cbranch_scc0 F_rdy19
    s_sleep 4
    s_sub_u32 s65, s65, 1
    s_cmp_lg_u32 s65, 0
    s_cbranch_scc1 F_look19
F_rdy19:
    s_add_u32 s65, s61, s7
    s_add_u32 s64, s65, 4096
    s_add_u32 m0, s59, 0
    s_nop 0
    buffer_load_dwordx4 v1, s[24:27], s65 offen offset:0 sc1 lds
    buffer_load_dwordx4 v1, s[24:27], s65 offen offset:1024 sc1 lds
    buffer_load_dwordx4 v1, s[24:27], s65 offen offset:2048 sc1 lds
    buffer_load_dwordx4 v1, s[24:27], s65 offen offset:3072 sc1 lds
    s_add_u32 m0, s59, 4096
    s_nop 0
    buffer_load_dwordx4 v1, s[24:27], s64 offen offset:0 sc1 lds
    buffer_load_dwordx4 v1, s[24:27], s64 offen offset:1024 sc1 lds
    buffer_load_dwordx4 v1, s[24:27], s64 offen offset:2048 sc1 lds
    buffer_load_dwordx4 v1, s[24:27], s64 offen offset:3072 sc1 lds
    s_add_u32 s61, s61, 32768
    s_and_b32 s61, s61, 262143
    s_add_u32 s59, s59, 32768
    s_cmp_eq_u32 s59, s57
    s_cselect_b32 s59, s60, s59
    s_xor_b32 s64, s4, 0
    s_lshl_b32 s64, s64, 6
    s_lshl_b32 s65, s3, 2
    s_add_u32 s64, s64, s65
    s_add_u32 s64, s64, s6
    s_lshl_b32 s64, s64, 13
    s_add_u32 s64, s64, 5242880
    s_waitcnt lgkmcnt(0)
    buffer_store_dwordx4 v[28:31], v223, s[24:27], s64 offen offset:0 sc1
    buffer_store_dwordx4 v[32:35], v223, s[24:27], s64 offen offset:128 sc1
    buffer_store_dwordx4 v[36:39], v223, s[24:27], s64 offen offset:256 sc1
    buffer_store_dwordx4 v[40:43], v223, s[24:27], s64 offen offset:512 sc1
    buffer_store_dwordx4 v[44:47], v223, s[24:27], s64 offen offset:640 sc1
    buffer_store_dwordx4 v[48:51], v223, s[24:27], s64 offen offset:768 sc1
    buffer_store_dwordx4 v[52:55], v223, s[24:27], s64 offen offset:896 sc1
    s_waitcnt vmcnt(7)
    s_barrier
    s_xor_b32 s64, s4, 0
    s_lshl_b32 s64, s64, 4
    s_add_u32 s64, s64, s3
    s_lshl_b32 s64, s64, 5
    s_add_u32 s64, s64, s6
    s_lshl_b32 s64, s64, 2
    s_add_u32 s64, s64, 4857856
    s_waitcnt vmcnt(0)
    v_mov_b32 v8, 0
    buffer_store_dword v8, v8, s[24:27], s64 offen sc1
    s_bfe_u32 s64, s71, 524296
    s_cbranch_scc0 F_rdy20
    s_mov_b32 s65, 30000
F_look20:
    buffer_load_dword v2, v213, s[24:27], s62 offen sc1
    s_waitcnt vmcnt(0)
    v_cmp_eq_u32 s[70:71], -1, v2
    s_nop 4
    s_bfe_u32 s64, s71, 524296
    s_cbranch_scc0 F_rdy20
    s_sleep 4
    s_sub_u32 s65, s65, 1
    s_cmp_lg_u32 s65, 0
    s_cbranch_scc1 F_look20
F_rdy20:
    s_add_u32 s65, s61, s7
    s_add_u32 s64, s65, 4096
    s_add_u32 m0, s59, 0
    s_nop 0
    buffer_load_dwordx4 v1, s[24:27], s65 offen offset:0 sc1 lds
    buffer_load_dwordx4 v1, s[24:27], s65 offen offset:1024 sc1 lds
    buffer_load_dwordx4 v1, s[24:27], s65 offen offset:2048 sc1 lds
    buffer_load_dwordx4 v1, s[24:27], s65 offen offset:3072 sc1 lds
    s_add_u32 m0, s59, 4096
    s_nop 0
    buffer_load_dwordx4 v1, s[24:27], s64 offen offset:0 sc1 lds
    buffer_load_dwordx4 v1, s[24:27], s64 offen offset:1024 sc1 lds
    buffer_load_dwordx4 v1, s[24:27], s64 offen offset:2048 sc1 lds
    buffer_load_dwordx4 v1, s[24:27], s64 offen offset:3072 sc1 lds
    s_add_u32 s61, s61, 32768
    s_and_b32 s61, s61, 262143
    s_add_u32 s59, s59, 32768
    s_cmp_eq_u32 s59, s57
    s_cselect_b32 s59, s60, s59
    s_lshl_b32 s64, s2, 2
    s_add_u32 s64, s64, s6
    s_lshl_b32 s64, s64, 13
    v_lshl_add_u32 v8, v0, 7, s64
    buffer_load_dword v11, v8, s[28:31], 0 offen
    s_waitcnt vmcnt(1)
    s_barrier
    s_bfe_u32 s64, s71, 524304
    s_cbranch_scc0 F_rdy21
    s_mov_b32 s65, 30000
F_look21:
    buffer_load_dword v2, v213, s[24:27], s62 offen sc1
    s_waitcnt vmcnt(0)
    v_cmp_eq_u32 s[70:71], -1, v2
    s_nop 4
    s_bfe_u32 s64, s71, 524304
    s_cbranch_scc0 F_rdy21
    s_sleep 4
    s_sub_u32 s65, s65, 1
    s_cmp_lg_u32 s65, 0
    s_cbranch_scc1 F_look21
F_rdy21:
    s_add_u32 s65, s61, s7
    s_add_u32 s64, s65, 4096
    s_add_u32 m0, s59, 0
    s_nop 0
    buffer_load_dwordx4 v1, s[24:27], s65 offen offset:0 sc1 lds
    buffer_load_dwordx4 v1, s[24:27], s65 offen offset:1024 sc1 lds
    buffer_load_dwordx4 v1, s[24:27], s65 offen offset:2048 sc1 lds
    buffer_load_dwordx4 v1, s[24:27], s65 offen offset:3072 sc1 lds
    s_add_u32 m0, s59, 4096
    s_nop 0
    buffer_load_dwordx4 v1, s[24:27], s64 offen offset:0 sc1 lds
    buffer_load_dwordx4 v1, s[24:27], s64 offen offset:1024 sc1 lds
    buffer_load_dwordx4 v1, s[24:27], s64 offen offset:2048 sc1 lds
    buffer_load_dwordx4 v1, s[24:27], s64 offen offset:3072 sc1 lds
    s_add_u32 s61, s61, 32768
    s_and_b32 s61, s61, 262143
    s_add_u32 s59, s59, 32768
    s_cmp_eq_u32 s59, s57
    s_cselect_b32 s59, s60, s59
    s_lshl_b32 s66, s3, 9
    s_add_u32 s66, s66, 4718592
    v_lshlrev_b32 v8, 3, v0
    s_mov_b32 s69, 30000
F_poll22:
    buffer_load_dwordx2 v[4:5], v8, s[24:27], s66 offen sc1
    s_waitcnt vmcnt(0)
    v_max_u32 v3, v4, v5
    v_cmp_eq_u32 vcc, -1, v3
    s_nop 4
    s_cbranch_vccz F_done22
    s_sleep 2
    s_sub_u32 s69, s69, 1
    s_cmp_lg_u32 s69, 0
    s_cbranch_scc1 F_poll22
F_done22:
    v_lshlrev_b32 v2, 1, v210
    v_xor_b32 v3, 8, v2
    v_lshlrev_b32 v4, 1, v2
    v_lshlrev_b32 v5, 1, v3
    s_lshl_b32 s64, s3, 2
    s_add_u32 s64, s64, s6
    s_lshl_b32 s64, s64, 6
    s_lshl_b32 s65, s64, 1
    s_add_u32 s65, s65, 4718592
    buffer_load_ushort v124, v2, s[32:35], s64 offen
    buffer_load_dword v132, v4, s[24:27], s65 offen sc1
    buffer_load_ushort v126, v3, s[32:35], s64 offen
    buffer_load_dword v134, v5, s[24:27], s65 offen sc1
    s_waitcnt vmcnt(0)
    v_sub_f32 v132, 1.0, v132
    v_lshlrev_b32 v124, 16, v124
    v_mov_b32 v133, v132
    v_mul_f32 v124, v124, v132
    v_mov_b32 v125, v124
    v_sub_f32 v134, 1.0, v134
    v_lshlrev_b32 v126, 16, v126
    v_mov_b32 v135, v134
    v_mul_f32 v126, v126, v134
    v_mov_b32 v127, v126
    s_lshl_b32 s64, s2, 2
    s_add_u32 s64, s64, s6
    s_lshl_b32 s64, s64, 13
    v_lshl_add_u32 v8, v0, 7, s64
    buffer_load_dword v11, v8, s[44:47], 0 offen
    v_subrev_u32 v9, 4194304, v8
    buffer_load_dword v11, v9, s[40:43], 0 offen
    s_barrier
    s_bfe_u32 s64, s71, 524312
    s_cbranch_scc0 F_rdy23
    s_mov_b32 s65, 30000
F_look23:
    buffer_load_dword v2, v213, s[24:27], s62 offen sc1
    s_waitcnt vmcnt(0)
    v_cmp_eq_u32 s[70:71], -1, v2
    s_nop 4
    s_bfe_u32 s64, s71, 524312
    s_cbranch_scc0 F_rdy23
    s_sleep 4
    s_sub_u32 s65, s65, 1
    s_cmp_lg_u32 s65, 0
    s_cbranch_scc1 F_look23
F_rdy23:
    s_add_u32 s65, s61, s7
    s_add_u32 s64, s65, 4096
    s_add_u32 m0, s59, 0
    s_nop 0
    buffer_load_dwordx4 v1, s[24:27], s65 offen offset:0 sc1 lds
    buffer_load_dwordx4 v1, s[24:27], s65 offen offset:1024 sc1 lds
    buffer_load_dwordx4 v1, s[24:27], s65 offen offset:2048 sc1 lds
    buffer_load_dwordx4 v1, s[24:27], s65 offen offset:3072 sc1 lds
    s_add_u32 m0, s59, 4096
    s_nop 0
    buffer_load_dwordx4 v1, s[24:27], s64 offen offset:0 sc1 lds
    buffer_load_dwordx4 v1, s[24:27], s64 offen offset:1024 sc1 lds
    buffer_load_dwordx4 v1, s[24:27], s64 offen offset:2048 sc1 lds
    buffer_load_dwordx4 v1, s[24:27], s64 offen offset:3072 sc1 lds
    s_add_u32 s61, s61, 32768
    s_and_b32 s61, s61, 262143
    s_add_u32 s59, s59, 32768
    s_cmp_eq_u32 s59, s57
    s_cselect_b32 s59, s60, s59
    s_cmp_ge_u32 s6, 2
    s_cbranch_scc1 F_hz
    s_and_b32 s7, s6, 1
    s_lshl_b32 s62, s3, 19
    s_lshl_b32 s64, s7, 18
    s_add_u32 s62, s62, s64
    s_add_u32 s62, s62, 0
    s_lshl_b32 s7, s7, 13
    s_mov_b32 s59, 0
    s_mov_b32 s58, 3
F_t00:
    s_add_u32 s65, s59, s7
    s_add_u32 s64, s62, 131072
    s_add_u32 m0, s65, 0
    s_nop 0
    buffer_load_dwordx4 v219, s[28:31], s62 offen lds
    s_add_u32 m0, s65, 1024
    s_nop 0
    buffer_load_dwordx4 v220, s[28:31], s62 offen lds
    s_add_u32 m0, s65, 2048
    s_nop 0
    buffer_load_dwordx4 v221, s[28:31], s62 offen lds
    s_add_u32 m0, s65, 3072
    s_nop 0
    buffer_load_dwordx4 v222, s[28:31], s62 offen lds
    s_add_u32 m0, s65, 4096
    s_nop 0
    buffer_load_dwordx4 v219, s[28:31], s64 offen lds
    s_add_u32 m0, s65, 5120
    s_nop 0
    buffer_load_dwordx4 v220, s[28:31], s64 offen lds
    s_add_u32 m0, s65, 6144
    s_nop 0
    buffer_load_dwordx4 v221, s[28:31], s64 offen lds
    s_add_u32 m0, s65, 7168
    s_nop 0
    buffer_load_dwordx4 v222, s[28:31], s64 offen lds
    s_add_u32 s62, s62, 128
    s_add_u32 s59, s59, 30720
    s_cmp_eq_u32 s59, 122880
    s_cselect_b32 s59, 0, s59
    s_sub_u32 s58, s58, 1
    s_cmp_lg_u32 s58, 0
    s_cbranch_scc1 F_t00
    s_waitcnt vmcnt(24)
    s_barrier
    s_add_u32 s65, s59, s7
    s_add_u32 s64, s62, 131072
    s_add_u32 m0, s65, 0
    s_nop 0
    buffer_load_dwordx4 v219, s[28:31], s62 offen lds
    s_add_u32 m0, s65, 1024
    s_nop 0
    buffer_load_dwordx4 v220, s[28:31], s62 offen lds
    s_add_u32 m0, s65, 2048
    s_nop 0
    buffer_load_dwordx4 v221, s[28:31], s62 offen lds
    s_add_u32 m0, s65, 3072
    s_nop 0
    buffer_load_dwordx4 v222, s[28:31], s62 offen lds
    s_add_u32 m0, s65, 4096
    s_nop 0
    buffer_load_dwordx4 v219, s[28:31], s64 offen lds
    s_add_u32 m0, s65, 5120
    s_nop 0
    buffer_load_dwordx4 v220, s[28:31], s64 offen lds
    s_add_u32 m0, s65, 6144
    s_nop 0
    buffer_load_dwordx4 v221, s[28:31], s64 offen lds
    s_add_u32 m0, s65, 7168
    s_nop 0
    buffer_load_dwordx4 v222, s[28:31], s64 offen lds
    s_add_u32 s62, s62, 128
    s_add_u32 s59, s59, 30720
    s_cmp_eq_u32 s59, 122880
    s_cselect_b32 s59, 0, s59
    s_getpc_b64 s[64:65]
F_pc24:
    s_sub_u32 s64, s64, F_pc24-gated_mix__grouped_kv_mqa__mixer_gmlp__prompt_kernel
    s_subb_u32 s65, s65, 0
    s_bfe_u32 s66, s2, 0x30003
    s_lshl_b32 s66, s66, 13
    v_lshl_add_u32 v4, v0, 7, s66
    v_min_u32 v4, F_exit-gated_mix__grouped_kv_mqa__mixer_gmlp__prompt_kernel, v4
    global_load_dword v4, v4, s[64:65]
    s_branch F_hy
F_hz:
    s_lshl_b32 s73, s4, 11
    s_add_u32 s73, s73, 4857856
    s_mov_b32 s69, 30000
F_poll25:
    buffer_load_dword v4, v226, s[24:27], s73 offen sc1
    s_waitcnt vmcnt(0)
    v_cmp_eq_u32 vcc, -1, v4
    s_nop 4
    s_cbranch_vccz F_done25
    s_sleep 2
    s_sub_u32 s69, s69, 1
    s_cmp_lg_u32 s69, 0
    s_cbranch_scc1 F_poll25
F_done25:
    s_and_b32 s7, s6, 1
    s_lshl_b32 s62, s4, 6
    s_add_u32 s62, s62, s7
    s_lshl_b32 s62, s62, 13
    s_add_u32 s62, s62, 5242880
    s_mul_i32 s7, s7, 7168
    s_add_u32 s7, s7, 16384
    s_mov_b32 s59, 0
    s_mov_b32 s58, 3
F_t01:
    s_add_u32 s65, s59, s7
    s_add_u32 m0, s65, 0
    s_nop 0
    buffer_load_dwordx4 v223, s[24:27], s62 offen offset:0 sc1 lds
    s_add_u32 m0, s65, 896
    s_nop 0
    buffer_load_dwordx4 v223, s[24:27], s62 offen offset:128 sc1 lds
    s_add_u32 m0, s65, 1792
    s_nop 0
    buffer_load_dwordx4 v223, s[24:27], s62 offen offset:256 sc1 lds
    s_add_u32 m0, s65, 2560
    s_nop 0
    buffer_load_dwordx4 v223, s[24:27], s62 offen offset:512 sc1 lds
    s_add_u32 m0, s65, 3456
    s_nop 0
    buffer_load_dwordx4 v223, s[24:27], s62 offen offset:640 sc1 lds
    s_add_u32 m0, s65, 4352
    s_nop 0
    buffer_load_dwordx4 v223, s[24:27], s62 offen offset:768 sc1 lds
    s_add_u32 m0, s65, 5248
    s_nop 0
    buffer_load_dwordx4 v223, s[24:27], s62 offen offset:896 sc1 lds
    s_add_u32 s62, s62, 16384
    s_add_u32 s59, s59, 30720
    s_cmp_eq_u32 s59, 122880
    s_cselect_b32 s59, 0, s59
    s_sub_u32 s58, s58, 1
    s_cmp_lg_u32 s58, 0
    s_cbranch_scc1 F_t01
    s_waitcnt vmcnt(21)
    s_barrier
    s_add_u32 s65, s59, s7
    s_add_u32 m0, s65, 0
    s_nop 0
    buffer_load_dwordx4 v223, s[24:27], s62 offen offset:0 sc1 lds
    s_add_u32 m0, s65, 896
    s_nop 0
    buffer_load_dwordx4 v223, s[24:27], s62 offen offset:128 sc1 lds
    s_add_u32 m0, s65, 1792
    s_nop 0
    buffer_load_dwordx4 v223, s[24:27], s62 offen offset:256 sc1 lds
    s_add_u32 m0, s65, 2560
    s_nop 0
    buffer_load_dwordx4 v223, s[24:27], s62 offen offset:512 sc1 lds
    s_add_u32 m0, s65, 3456
    s_nop 0
    buffer_load_dwordx4 v223, s[24:27], s62 offen offset:640 sc1 lds
    s_add_u32 m0, s65, 4352
    s_nop 0
    buffer_load_dwordx4 v223, s[24:27], s62 offen offset:768 sc1 lds
    s_add_u32 m0, s65, 5248
    s_nop 0
    buffer_load_dwordx4 v223, s[24:27], s62 offen offset:896 sc1 lds
    s_add_u32 s62, s62, 16384
    s_add_u32 s59, s59, 30720
    s_cmp_eq_u32 s59, 122880
    s_cselect_b32 s59, 0, s59
F_hy:
    s_setprio 0
    s_waitcnt vmcnt(0)
    s_barrier
    ds_read_b128 v[92:95], v206 offset:0
    ds_read_b128 v[20:23], v208 offset:0
    ds_read_b128 v[100:103], v207 offset:0
    ds_read_b128 v[48:51], v208 offset:7168
    ds_read_b128 v[104:107], v207 offset:2048
    ds_read_b128 v[96:99], v206 offset:2048
    ds_read_b128 v[24:27], v208 offset:1024
    ds_read_b128 v[52:55], v208 offset:8192
    ds_read_b128 v[28:31], v208 offset:2048
    ds_read_b128 v[56:59], v208 offset:9216
    ds_read_b128 v[32:35], v208 offset:3072
    ds_read_b128 v[60:63], v208 offset:10240
    s_mov_b32 s56, 0
    s_mov_b32 s58, 16
    s_mov_b32 s5, s6
    s_lshr_b32 s6, s5, 1
    s_and_b32 s7, s5, 1
    s_lshl_b32 s61, s3, 2
    s_add_u32 s61, s61, s5
    s_mul_i32 s61, s61, 212992
    s_lshl_b32 s64, s4, 12
    s_add_u32 s61, s61, s64
    s_add_u32 s61, s61, 13672448
    .p2align 6
F_c3:
    s_waitcnt lgkmcnt(4)
    v_mfma_f32_16x16x32_bf16 v[148:151], v[20:23], v[92:95], v[148:151]
    ds_read_b128 v[36:39], v208 offset:4096
    v_mfma_f32_16x16x32_bf16 v[148:151], v[48:51], v[100:103], v[148:151]
    ds_read_b128 v[64:67], v208 offset:11264
    v_mfma_f32_16x16x32_bf16 v[152:155], v[48:51], v[104:107], v[152:155]
    ds_read_b128 v[40:43], v208 offset:5120
    v_mfma_f32_16x16x32_bf16 v[152:155], v[20:23], v[96:99], v[152:155]
    ds_read_b128 v[68:71], v208 offset:12288
    v_mfma_f32_16x16x32_bf16 v[160:163], v[24:27], v[96:99], v[160:163]
    ds_read_b128 v[44:47], v208 offset:6144
    v_mfma_f32_16x16x32_bf16 v[160:163], v[52:55], v[104:107], v[160:163]
    ds_read_b128 v[72:75], v208 offset:13312
    v_mfma_f32_16x16x32_bf16 v[156:159], v[52:55], v[100:103], v[156:159]
    v_mfma_f32_16x16x32_bf16 v[156:159], v[24:27], v[92:95], v[156:159]
    s_waitcnt lgkmcnt(6)
    v_mfma_f32_16x16x32_bf16 v[164:167], v[28:31], v[92:95], v[164:167]
    s_add_u32 s56, s56, 30720
    s_cmp_eq_u32 s56, 122880
    v_mfma_f32_16x16x32_bf16 v[164:167], v[56:59], v[100:103], v[164:167]
    s_cselect_b32 s56, 0, s56
    v_mfma_f32_16x16x32_bf16 v[168:171], v[56:59], v[104:107], v[168:171]
    v_add_u32 v206, s56, v204
    v_add_u32 v208, s56, v205
    v_mfma_f32_16x16x32_bf16 v[168:171], v[28:31], v[96:99], v[168:171]
    v_xor_b32 v207, 64, v206
    v_mfma_f32_16x16x32_bf16 v[176:179], v[32:35], v[96:99], v[176:179]
    v_mfma_f32_16x16x32_bf16 v[176:179], v[60:63], v[104:107], v[176:179]
    s_waitcnt lgkmcnt(0)
    v_mfma_f32_16x16x32_bf16 v[172:175], v[60:63], v[100:103], v[172:175]
    v_mfma_f32_16x16x32_bf16 v[172:175], v[32:35], v[92:95], v[172:175]
    s_barrier
    v_mfma_f32_16x16x32_bf16 v[180:183], v[36:39], v[92:95], v[180:183]
    ds_read_b128 v[108:111], v206 offset:0
    v_mfma_f32_16x16x32_bf16 v[180:183], v[64:67], v[100:103], v[180:183]
    ds_read_b128 v[20:23], v208 offset:0
    v_mfma_f32_16x16x32_bf16 v[184:187], v[64:67], v[104:107], v[184:187]
    ds_read_b128 v[116:119], v207 offset:0
    v_mfma_f32_16x16x32_bf16 v[184:187], v[36:39], v[96:99], v[184:187]
    ds_read_b128 v[48:51], v208 offset:7168
    v_mfma_f32_16x16x32_bf16 v[192:195], v[40:43], v[96:99], v[192:195]
    ds_read_b128 v[120:123], v207 offset:2048
    v_mfma_f32_16x16x32_bf16 v[192:195], v[68:71], v[104:107], v[192:195]
    ds_read_b128 v[112:115], v206 offset:2048
    v_mfma_f32_16x16x32_bf16 v[188:191], v[68:71], v[100:103], v[188:191]
    ds_read_b128 v[24:27], v208 offset:1024
    v_mfma_f32_16x16x32_bf16 v[188:191], v[40:43], v[92:95], v[188:191]
    ds_read_b128 v[52:55], v208 offset:8192
    v_mfma_f32_16x16x32_bf16 v[196:199], v[44:47], v[92:95], v[196:199]
    ds_read_b128 v[28:31], v208 offset:2048
    v_mfma_f32_16x16x32_bf16 v[196:199], v[72:75], v[100:103], v[196:199]
    ds_read_b128 v[56:59], v208 offset:9216
    v_mfma_f32_16x16x32_bf16 v[200:203], v[72:75], v[104:107], v[200:203]
    ds_read_b128 v[32:35], v208 offset:3072
    v_mfma_f32_16x16x32_bf16 v[200:203], v[44:47], v[96:99], v[200:203]
    ds_read_b128 v[60:63], v208 offset:10240
    s_waitcnt lgkmcnt(4)
    v_mfma_f32_16x16x32_bf16 v[148:151], v[20:23], v[108:111], v[148:151]
    ds_read_b128 v[36:39], v208 offset:4096
    v_mfma_f32_16x16x32_bf16 v[148:151], v[48:51], v[116:119], v[148:151]
    ds_read_b128 v[64:67], v208 offset:11264
    v_mfma_f32_16x16x32_bf16 v[152:155], v[48:51], v[120:123], v[152:155]
    ds_read_b128 v[40:43], v208 offset:5120
    v_mfma_f32_16x16x32_bf16 v[152:155], v[20:23], v[112:115], v[152:155]
    ds_read_b128 v[68:71], v208 offset:12288
    v_mfma_f32_16x16x32_bf16 v[160:163], v[24:27], v[112:115], v[160:163]
    ds_read_b128 v[44:47], v208 offset:6144
    v_mfma_f32_16x16x32_bf16 v[160:163], v[52:55], v[120:123], v[160:163]
    ds_read_b128 v[72:75], v208 offset:13312
    v_mfma_f32_16x16x32_bf16 v[156:159], v[52:55], v[116:119], v[156:159]
    v_mfma_f32_16x16x32_bf16 v[156:159], v[24:27], v[108:111], v[156:159]
    s_waitcnt lgkmcnt(6)
    v_mfma_f32_16x16x32_bf16 v[164:167], v[28:31], v[108:111], v[164:167]
    s_add_u32 s56, s56, 30720
    s_cmp_eq_u32 s56, 122880
    v_mfma_f32_16x16x32_bf16 v[164:167], v[56:59], v[116:119], v[164:167]
    s_cselect_b32 s56, 0, s56
    v_mfma_f32_16x16x32_bf16 v[168:171], v[56:59], v[120:123], v[168:171]
    v_add_u32 v206, s56, v204
    v_add_u32 v208, s56, v205
    v_mfma_f32_16x16x32_bf16 v[168:171], v[28:31], v[112:115], v[168:171]
    v_xor_b32 v207, 64, v206
    v_mfma_f32_16x16x32_bf16 v[176:179], v[32:35], v[112:115], v[176:179]
    v_mfma_f32_16x16x32_bf16 v[176:179], v[60:63], v[120:123], v[176:179]
    s_waitcnt lgkmcnt(0)
    v_mfma_f32_16x16x32_bf16 v[172:175], v[60:63], v[116:119], v[172:175]
    v_mfma_f32_16x16x32_bf16 v[172:175], v[32:35], v[108:111], v[172:175]
    s_barrier
    v_mfma_f32_16x16x32_bf16 v[180:183], v[36:39], v[108:111], v[180:183]
    ds_read_b128 v[92:95], v206 offset:0
    v_mfma_f32_16x16x32_bf16 v[180:183], v[64:67], v[116:119], v[180:183]
    ds_read_b128 v[20:23], v208 offset:0
    v_mfma_f32_16x16x32_bf16 v[184:187], v[64:67], v[120:123], v[184:187]
    ds_read_b128 v[100:103], v207 offset:0
    v_mfma_f32_16x16x32_bf16 v[184:187], v[36:39], v[112:115], v[184:187]
    ds_read_b128 v[48:51], v208 offset:7168
    v_mfma_f32_16x16x32_bf16 v[192:195], v[40:43], v[112:115], v[192:195]
    ds_read_b128 v[104:107], v207 offset:2048
    v_mfma_f32_16x16x32_bf16 v[192:195], v[68:71], v[120:123], v[192:195]
    ds_read_b128 v[96:99], v206 offset:2048
    v_mfma_f32_16x16x32_bf16 v[188:191], v[68:71], v[116:119], v[188:191]
    ds_read_b128 v[24:27], v208 offset:1024
    v_mfma_f32_16x16x32_bf16 v[188:191], v[40:43], v[108:111], v[188:191]
    ds_read_b128 v[52:55], v208 offset:8192
    v_mfma_f32_16x16x32_bf16 v[196:199], v[44:47], v[108:111], v[196:199]
    ds_read_b128 v[28:31], v208 offset:2048
    v_mfma_f32_16x16x32_bf16 v[196:199], v[72:75], v[116:119], v[196:199]
    ds_read_b128 v[56:59], v208 offset:9216
    v_mfma_f32_16x16x32_bf16 v[200:203], v[72:75], v[120:123], v[200:203]
    ds_read_b128 v[32:35], v208 offset:3072
    v_mfma_f32_16x16x32_bf16 v[200:203], v[44:47], v[112:115], v[200:203]
    ds_read_b128 v[60:63], v208 offset:10240
    s_sub_u32 s58, s58, 1
    s_cmp_lg_u32 s58, 0
    s_cbranch_scc1 F_c3
    s_setprio 3
    v_lshlrev_b32 v8, 16, v228
    v_and_b32 v9, 0xffff0000, v228
    v_pk_fma_f32 v[148:149], v[148:149], v[132:133], v[124:125]
    v_lshlrev_b32 v10, 16, v229
    v_and_b32 v11, 0xffff0000, v229
    v_pk_fma_f32 v[150:151], v[150:151], v[132:133], v[124:125]
    v_lshlrev_b32 v12, 16, v230
    v_and_b32 v13, 0xffff0000, v230
    v_pk_fma_f32 v[152:153], v[152:153], v[134:135], v[126:127]
    v_lshlrev_b32 v14, 16, v231
    v_and_b32 v15, 0xffff0000, v231
    v_pk_fma_f32 v[154:155], v[154:155], v[134:135], v[126:127]
    v_pk_mul_f32 v[8:9], v[8:9], v[148:149]
    v_pk_mul_f32 v[10:11], v[10:11], v[150:151]
    v_pk_mul_f32 v[12:13], v[12:13], v[152:153]
    v_pk_mul_f32 v[14:15], v[14:15], v[154:155]
    v_cvt_pk_bf16_f32 v228, v8, v9
    v_cvt_pk_bf16_f32 v229, v10, v11
    v_cvt_pk_bf16_f32 v230, v12, v13
    v_cvt_pk_bf16_f32 v231, v14, v15
    buffer_store_dwordx2 v[228:229], v128, s[24:27], s61 offen offset:0 sc1
    buffer_store_dwordx2 v[230:231], v129, s[24:27], s61 offen offset:0 sc1
    v_lshlrev_b32 v8, 16, v232
    v_and_b32 v9, 0xffff0000, v232
    v_pk_fma_f32 v[156:157], v[156:157], v[132:133], v[124:125]
    v_lshlrev_b32 v10, 16, v233
    v_and_b32 v11, 0xffff0000, v233
    v_pk_fma_f32 v[158:159], v[158:159], v[132:133], v[124:125]
    v_lshlrev_b32 v12, 16, v234
    v_and_b32 v13, 0xffff0000, v234
    v_pk_fma_f32 v[160:161], v[160:161], v[134:135], v[126:127]
    v_lshlrev_b32 v14, 16, v235
    v_and_b32 v15, 0xffff0000, v235
    v_pk_fma_f32 v[162:163], v[162:163], v[134:135], v[126:127]
    v_pk_mul_f32 v[8:9], v[8:9], v[156:157]
    v_pk_mul_f32 v[10:11], v[10:11], v[158:159]
    v_pk_mul_f32 v[12:13], v[12:13], v[160:161]
    v_pk_mul_f32 v[14:15], v[14:15], v[162:163]
    v_cvt_pk_bf16_f32 v232, v8, v9
    v_cvt_pk_bf16_f32 v233, v10, v11
    v_cvt_pk_bf16_f32 v234, v12, v13
    v_cvt_pk_bf16_f32 v235, v14, v15
    buffer_store_dwordx2 v[232:233], v128, s[24:27], s61 offen offset:128 sc1
    buffer_store_dwordx2 v[234:235], v129, s[24:27], s61 offen offset:128 sc1
    v_lshlrev_b32 v8, 16, v236
    v_and_b32 v9, 0xffff0000, v236
    v_pk_fma_f32 v[164:165], v[164:165], v[132:133], v[124:125]
    v_lshlrev_b32 v10, 16, v237
    v_and_b32 v11, 0xffff0000, v237
    v_pk_fma_f32 v[166:167], v[166:167], v[132:133], v[124:125]
    v_lshlrev_b32 v12, 16, v238
    v_and_b32 v13, 0xffff0000, v238
    v_pk_fma_f32 v[168:169], v[168:169], v[134:135], v[126:127]
    v_lshlrev_b32 v14, 16, v239
    v_and_b32 v15, 0xffff0000, v239
    v_pk_fma_f32 v[170:171], v[170:171], v[134:135], v[126:127]
    v_pk_mul_f32 v[8:9], v[8:9], v[164:165]
    v_pk_mul_f32 v[10:11], v[10:11], v[166:167]
    v_pk_mul_f32 v[12:13], v[12:13], v[168:169]
    v_pk_mul_f32 v[14:15], v[14:15], v[170:171]
    v_cvt_pk_bf16_f32 v236, v8, v9
    v_cvt_pk_bf16_f32 v237, v10, v11
    v_cvt_pk_bf16_f32 v238, v12, v13
    v_cvt_pk_bf16_f32 v239, v14, v15
    buffer_store_dwordx2 v[236:237], v128, s[24:27], s61 offen offset:256 sc1
    buffer_store_dwordx2 v[238:239], v129, s[24:27], s61 offen offset:256 sc1
    v_lshlrev_b32 v8, 16, v240
    v_and_b32 v9, 0xffff0000, v240
    v_pk_fma_f32 v[172:173], v[172:173], v[132:133], v[124:125]
    v_lshlrev_b32 v10, 16, v241
    v_and_b32 v11, 0xffff0000, v241
    v_pk_fma_f32 v[174:175], v[174:175], v[132:133], v[124:125]
    v_lshlrev_b32 v12, 16, v242
    v_and_b32 v13, 0xffff0000, v242
    v_pk_fma_f32 v[176:177], v[176:177], v[134:135], v[126:127]
    v_lshlrev_b32 v14, 16, v243
    v_and_b32 v15, 0xffff0000, v243
    v_pk_fma_f32 v[178:179], v[178:179], v[134:135], v[126:127]
    v_pk_mul_f32 v[8:9], v[8:9], v[172:173]
    v_pk_mul_f32 v[10:11], v[10:11], v[174:175]
    v_pk_mul_f32 v[12:13], v[12:13], v[176:177]
    v_pk_mul_f32 v[14:15], v[14:15], v[178:179]
    v_cvt_pk_bf16_f32 v240, v8, v9
    v_cvt_pk_bf16_f32 v241, v10, v11
    v_cvt_pk_bf16_f32 v242, v12, v13
    v_cvt_pk_bf16_f32 v243, v14, v15
    buffer_store_dwordx2 v[240:241], v128, s[24:27], s61 offen offset:512 sc1
    buffer_store_dwordx2 v[242:243], v129, s[24:27], s61 offen offset:512 sc1
    v_lshlrev_b32 v8, 16, v244
    v_and_b32 v9, 0xffff0000, v244
    v_pk_fma_f32 v[180:181], v[180:181], v[132:133], v[124:125]
    v_lshlrev_b32 v10, 16, v245
    v_and_b32 v11, 0xffff0000, v245
    v_pk_fma_f32 v[182:183], v[182:183], v[132:133], v[124:125]
    v_lshlrev_b32 v12, 16, v246
    v_and_b32 v13, 0xffff0000, v246
    v_pk_fma_f32 v[184:185], v[184:185], v[134:135], v[126:127]
    v_lshlrev_b32 v14, 16, v247
    v_and_b32 v15, 0xffff0000, v247
    v_pk_fma_f32 v[186:187], v[186:187], v[134:135], v[126:127]
    v_pk_mul_f32 v[8:9], v[8:9], v[180:181]
    v_pk_mul_f32 v[10:11], v[10:11], v[182:183]
    v_pk_mul_f32 v[12:13], v[12:13], v[184:185]
    v_pk_mul_f32 v[14:15], v[14:15], v[186:187]
    v_cvt_pk_bf16_f32 v244, v8, v9
    v_cvt_pk_bf16_f32 v245, v10, v11
    v_cvt_pk_bf16_f32 v246, v12, v13
    v_cvt_pk_bf16_f32 v247, v14, v15
    buffer_store_dwordx2 v[244:245], v128, s[24:27], s61 offen offset:640 sc1
    buffer_store_dwordx2 v[246:247], v129, s[24:27], s61 offen offset:640 sc1
    v_lshlrev_b32 v8, 16, v248
    v_and_b32 v9, 0xffff0000, v248
    v_pk_fma_f32 v[188:189], v[188:189], v[132:133], v[124:125]
    v_lshlrev_b32 v10, 16, v249
    v_and_b32 v11, 0xffff0000, v249
    v_pk_fma_f32 v[190:191], v[190:191], v[132:133], v[124:125]
    v_lshlrev_b32 v12, 16, v250
    v_and_b32 v13, 0xffff0000, v250
    v_pk_fma_f32 v[192:193], v[192:193], v[134:135], v[126:127]
    v_lshlrev_b32 v14, 16, v251
    v_and_b32 v15, 0xffff0000, v251
    v_pk_fma_f32 v[194:195], v[194:195], v[134:135], v[126:127]
    v_pk_mul_f32 v[8:9], v[8:9], v[188:189]
    v_pk_mul_f32 v[10:11], v[10:11], v[190:191]
    v_pk_mul_f32 v[12:13], v[12:13], v[192:193]
    v_pk_mul_f32 v[14:15], v[14:15], v[194:195]
    v_cvt_pk_bf16_f32 v248, v8, v9
    v_cvt_pk_bf16_f32 v249, v10, v11
    v_cvt_pk_bf16_f32 v250, v12, v13
    v_cvt_pk_bf16_f32 v251, v14, v15
    buffer_store_dwordx2 v[248:249], v128, s[24:27], s61 offen offset:768 sc1
    buffer_store_dwordx2 v[250:251], v129, s[24:27], s61 offen offset:768 sc1
    v_lshlrev_b32 v8, 16, v252
    v_and_b32 v9, 0xffff0000, v252
    v_pk_fma_f32 v[196:197], v[196:197], v[132:133], v[124:125]
    v_lshlrev_b32 v10, 16, v253
    v_and_b32 v11, 0xffff0000, v253
    v_pk_fma_f32 v[198:199], v[198:199], v[132:133], v[124:125]
    v_lshlrev_b32 v12, 16, v254
    v_and_b32 v13, 0xffff0000, v254
    v_pk_fma_f32 v[200:201], v[200:201], v[134:135], v[126:127]
    v_lshlrev_b32 v14, 16, v255
    v_and_b32 v15, 0xffff0000, v255
    v_pk_fma_f32 v[202:203], v[202:203], v[134:135], v[126:127]
    v_pk_mul_f32 v[8:9], v[8:9], v[196:197]
    v_pk_mul_f32 v[10:11], v[10:11], v[198:199]
    v_pk_mul_f32 v[12:13], v[12:13], v[200:201]
    v_pk_mul_f32 v[14:15], v[14:15], v[202:203]
    v_cvt_pk_bf16_f32 v252, v8, v9
    v_cvt_pk_bf16_f32 v253, v10, v11
    v_cvt_pk_bf16_f32 v254, v12, v13
    v_cvt_pk_bf16_f32 v255, v14, v15
    buffer_store_dwordx2 v[252:253], v128, s[24:27], s61 offen offset:896 sc1
    buffer_store_dwordx2 v[254:255], v129, s[24:27], s61 offen offset:896 sc1
    s_setprio 0
    s_waitcnt lgkmcnt(0)
    s_mov_b32 s56, 126976
    s_lshl_b32 s66, s6, 12
    s_add_u32 s66, s66, 8192
    v_lshl_add_u32 v204, v0, 3, s66
    v_lshrrev_b32 v2, 2, v0
    v_bfe_u32 v3, v2, 1, 2
    s_lshl_b32 s66, s7, 1
    v_xor_b32 v3, s66, v3
    v_lshlrev_b32 v3, 5, v3
    v_lshl_add_u32 v3, v2, 7, v3
    v_and_b32 v2, 3, v0
    v_lshl_add_u32 v205, v2, 3, v3
    v_add_u32 v206, s56, v204
    v_add_u32 v208, s56, v205
    v_xor_b32 v209, 32, v208
    ds_read_b64_tr_b16 v[180:181], v208 offset:0
    ds_read_b64_tr_b16 v[182:183], v208 offset:2048
    ds_read_b64_tr_b16 v[188:189], v208 offset:4096
    ds_read_b64_tr_b16 v[190:191], v208 offset:6144
    ds_read_b64_tr_b16 v[184:185], v209 offset:0
    ds_read_b64_tr_b16 v[186:187], v209 offset:2048
    ds_read_b64_tr_b16 v[192:193], v209 offset:4096
    ds_read_b64_tr_b16 v[194:195], v209 offset:6144
    ds_read2st64_b64 v[148:151], v206 offset0:0 offset1:1
    ds_read2st64_b64 v[164:167], v206 offset0:16 offset1:17
    ds_read2st64_b64 v[168:171], v206 offset0:18 offset1:19
    ds_read2st64_b64 v[152:155], v206 offset0:2 offset1:3
    v_mov_b32 v4, 0
    v_mov_b32 v5, 0
    v_mov_b32 v6, 0
    v_mov_b32 v7, 0
    s_mov_b32 s58, 1
    s_mov_b32 s63, 0
    v_mfma_f32_32x32x16_bf16 v[8:23], v[4:7], v[4:7], 0
    v_mfma_f32_32x32x16_bf16 v[24:39], v[4:7], v[4:7], 0
    v_mfma_f32_32x32x16_bf16 v[40:55], v[4:7], v[4:7], 0
    v_mfma_f32_32x32x16_bf16 v[56:71], v[4:7], v[4:7], 0
    s_nop 3
    .p2align 6
F_c5:
    s_waitcnt lgkmcnt(3)
    v_mfma_f32_16x16x32_bf16 v[8:11], v[180:183], v[148:151], v[8:11]
    ds_read2st64_b64 v[156:159], v206 offset0:4 offset1:5
    s_waitcnt lgkmcnt(3)
    v_mfma_f32_16x16x32_bf16 v[8:11], v[188:191], v[164:167], v[8:11]
    ds_read2st64_b64 v[172:175], v206 offset0:20 offset1:21
    s_waitcnt lgkmcnt(3)
    v_mfma_f32_16x16x32_bf16 v[12:15], v[188:191], v[168:171], v[12:15]
    ds_read2st64_b64 v[176:179], v206 offset0:22 offset1:23
    s_waitcnt lgkmcnt(3)
    v_mfma_f32_16x16x32_bf16 v[12:15], v[180:183], v[152:155], v[12:15]
    ds_read2st64_b64 v[160:163], v206 offset0:6 offset1:7
    v_mfma_f32_16x16x32_bf16 v[28:31], v[184:187], v[152:155], v[28:31]
    ds_read_b64_tr_b16 v[72:73], v208 offset:24576
    v_mfma_f32_16x16x32_bf16 v[28:31], v[192:195], v[168:171], v[28:31]
    ds_read_b64_tr_b16 v[74:75], v208 offset:26624
    v_mfma_f32_16x16x32_bf16 v[24:27], v[192:195], v[164:167], v[24:27]
    ds_read_b64_tr_b16 v[80:81], v208 offset:28672
    v_mfma_f32_16x16x32_bf16 v[24:27], v[184:187], v[148:151], v[24:27]
    ds_read_b64_tr_b16 v[82:83], v208 offset:30720
    s_waitcnt lgkmcnt(7)
    v_mfma_f32_16x16x32_bf16 v[16:19], v[180:183], v[156:159], v[16:19]
    ds_read_b64_tr_b16 v[76:77], v209 offset:24576
    s_waitcnt lgkmcnt(7)
    v_mfma_f32_16x16x32_bf16 v[16:19], v[188:191], v[172:175], v[16:19]
    ds_read_b64_tr_b16 v[78:79], v209 offset:26624
    s_waitcnt lgkmcnt(7)
    v_mfma_f32_16x16x32_bf16 v[20:23], v[188:191], v[176:179], v[20:23]
    ds_read_b64_tr_b16 v[84:85], v209 offset:28672
    s_waitcnt lgkmcnt(7)
    v_mfma_f32_16x16x32_bf16 v[20:23], v[180:183], v[160:163], v[20:23]
    ds_read_b64_tr_b16 v[86:87], v209 offset:30720
    v_mfma_f32_16x16x32_bf16 v[36:39], v[184:187], v[160:163], v[36:39]
    s_add_u32 s56, s56, 32768
    s_cmp_eq_u32 s56, 159744
    s_cselect_b32 s56, 0, s56
    v_mfma_f32_16x16x32_bf16 v[36:39], v[192:195], v[176:179], v[36:39]
    s_cmp_eq_u32 s56, 98304
    s_cselect_b32 s56, 126976, s56
    v_add_u32 v206, s56, v204
    v_mfma_f32_16x16x32_bf16 v[32:35], v[192:195], v[172:175], v[32:35]
    v_add_u32 v208, s56, v205
    v_xor_b32 v209, 32, v208
    v_mfma_f32_16x16x32_bf16 v[32:35], v[184:187], v[156:159], v[32:35]
    s_waitcnt lgkmcnt(0)
    s_barrier
    v_mfma_f32_16x16x32_bf16 v[40:43], v[72:75], v[148:151], v[40:43]
    ds_read_b64_tr_b16 v[180:181], v208 offset:0
    v_mfma_f32_16x16x32_bf16 v[40:43], v[80:83], v[164:167], v[40:43]
    ds_read_b64_tr_b16 v[182:183], v208 offset:2048
    v_mfma_f32_16x16x32_bf16 v[44:47], v[80:83], v[168:171], v[44:47]
    ds_read_b64_tr_b16 v[188:189], v208 offset:4096
    v_mfma_f32_16x16x32_bf16 v[44:47], v[72:75], v[152:155], v[44:47]
    ds_read_b64_tr_b16 v[190:191], v208 offset:6144
    v_mfma_f32_16x16x32_bf16 v[60:63], v[76:79], v[152:155], v[60:63]
    ds_read_b64_tr_b16 v[184:185], v209 offset:0
    v_mfma_f32_16x16x32_bf16 v[60:63], v[84:87], v[168:171], v[60:63]
    ds_read_b64_tr_b16 v[186:187], v209 offset:2048
    v_mfma_f32_16x16x32_bf16 v[56:59], v[84:87], v[164:167], v[56:59]
    ds_read_b64_tr_b16 v[192:193], v209 offset:4096
    v_mfma_f32_16x16x32_bf16 v[56:59], v[76:79], v[148:151], v[56:59]
    ds_read_b64_tr_b16 v[194:195], v209 offset:6144
    v_mfma_f32_16x16x32_bf16 v[48:51], v[72:75], v[156:159], v[48:51]
    ds_read2st64_b64 v[148:151], v206 offset0:0 offset1:1
    v_mfma_f32_16x16x32_bf16 v[48:51], v[80:83], v[172:175], v[48:51]
    ds_read2st64_b64 v[164:167], v206 offset0:16 offset1:17
    v_mfma_f32_16x16x32_bf16 v[52:55], v[80:83], v[176:179], v[52:55]
    ds_read2st64_b64 v[168:171], v206 offset0:18 offset1:19
    v_mfma_f32_16x16x32_bf16 v[52:55], v[72:75], v[160:163], v[52:55]
    ds_read2st64_b64 v[152:155], v206 offset0:2 offset1:3
    v_mfma_f32_16x16x32_bf16 v[68:71], v[76:79], v[160:163], v[68:71]
    v_mfma_f32_16x16x32_bf16 v[68:71], v[84:87], v[176:179], v[68:71]
    v_mfma_f32_16x16x32_bf16 v[64:67], v[84:87], v[172:175], v[64:67]
    v_mfma_f32_16x16x32_bf16 v[64:67], v[76:79], v[156:159], v[64:67]
    s_sub_u32 s58, s58, 1
    s_cmp_lg_u32 s58, 0
    s_cbranch_scc1 F_c5
    s_cmp_lg_u32 s63, 0
    s_cbranch_scc1 F_e5
    s_mov_b32 s63, 1
    s_mov_b32 s58, 19
    s_lshl_b32 s64, s3, 4
    s_add_u32 s64, s64, s4
    s_lshl_b32 s64, s64, 5
    s_and_b32 s65, s5, 3
    s_add_u32 s64, s64, s65
    s_lshl_b32 s64, s64, 2
    s_add_u32 s64, s64, 4792320
    s_waitcnt vmcnt(0)
    v_mov_b32 v2, 0
    buffer_store_dword v2, v2, s[24:27], s64 offen sc1
    s_branch F_c5
F_e5:
    s_mov_b32 s58, 3
    ds_read_b64_tr_b16 v[180:181], v208 offset:0
    ds_read_b64_tr_b16 v[182:183], v208 offset:2048
    ds_read2st64_b64 v[148:151], v206 offset0:0 offset1:1
    ds_read2st64_b64 v[152:155], v206 offset0:2 offset1:3
    ds_read2st64_b64 v[156:159], v206 offset0:4 offset1:5
    ds_read2st64_b64 v[160:163], v206 offset0:6 offset1:7
    ds_read_b64_tr_b16 v[184:185], v209 offset:0
    ds_read_b64_tr_b16 v[186:187], v209 offset:2048
    s_lshl_b32 s64, s2, 2
    s_add_u32 s64, s64, s5
    s_lshl_b32 s64, s64, 12
    s_add_u32 s64, s64, 28311552
    v_cvt_pk_bf16_f32 v72, v40, v41
    v_cvt_pk_bf16_f32 v73, v42, v43
    v_cvt_pk_bf16_f32 v74, v44, v45
    v_cvt_pk_bf16_f32 v75, v46, v47
    buffer_store_dwordx4 v[72:75], v1, s[24:27], s64 offen offset:0 sc1
    v_cvt_pk_bf16_f32 v76, v48, v49
    v_cvt_pk_bf16_f32 v77, v50, v51
    v_cvt_pk_bf16_f32 v78, v52, v53
    v_cvt_pk_bf16_f32 v79, v54, v55
    buffer_store_dwordx4 v[76:79], v1, s[24:27], s64 offen offset:1024 sc1
    v_cvt_pk_bf16_f32 v80, v56, v57
    v_cvt_pk_bf16_f32 v81, v58, v59
    v_cvt_pk_bf16_f32 v82, v60, v61
    v_cvt_pk_bf16_f32 v83, v62, v63
    buffer_store_dwordx4 v[80:83], v1, s[24:27], s64 offen offset:2048 sc1
    v_cvt_pk_bf16_f32 v84, v64, v65
    v_cvt_pk_bf16_f32 v85, v66, v67
    v_cvt_pk_bf16_f32 v86, v68, v69
    v_cvt_pk_bf16_f32 v87, v70, v71
    buffer_store_dwordx4 v[84:87], v1, s[24:27], s64 offen offset:3072 sc1
    .p2align 6
F_c4:
    s_waitcnt lgkmcnt(5)
    v_mfma_f32_16x16x32_bf16 v[8:11], v[180:183], v[148:151], v[8:11]
    ds_read_b64_tr_b16 v[188:189], v208 offset:4096
    ds_read_b64_tr_b16 v[190:191], v208 offset:6144
    s_waitcnt lgkmcnt(6)
    v_mfma_f32_16x16x32_bf16 v[12:15], v[180:183], v[152:155], v[12:15]
    ds_read2st64_b64 v[164:167], v206 offset0:16 offset1:17
    s_waitcnt lgkmcnt(6)
    v_mfma_f32_16x16x32_bf16 v[16:19], v[180:183], v[156:159], v[16:19]
    ds_read2st64_b64 v[168:171], v206 offset0:18 offset1:19
    ds_read2st64_b64 v[172:175], v206 offset0:20 offset1:21
    s_waitcnt lgkmcnt(7)
    v_mfma_f32_16x16x32_bf16 v[20:23], v[180:183], v[160:163], v[20:23]
    ds_read2st64_b64 v[176:179], v206 offset0:22 offset1:23
    s_waitcnt lgkmcnt(6)
    v_mfma_f32_16x16x32_bf16 v[24:27], v[184:187], v[148:151], v[24:27]
    ds_read_b64_tr_b16 v[192:193], v209 offset:4096
    ds_read_b64_tr_b16 v[194:195], v209 offset:6144
    v_mfma_f32_16x16x32_bf16 v[28:31], v[184:187], v[152:155], v[28:31]
    s_add_u32 s56, s56, 32768
    s_cmp_eq_u32 s56, 159744
    s_cselect_b32 s56, 0, s56
    v_mfma_f32_16x16x32_bf16 v[32:35], v[184:187], v[156:159], v[32:35]
    s_cmp_eq_u32 s56, 98304
    s_cselect_b32 s56, 126976, s56
    v_mfma_f32_16x16x32_bf16 v[36:39], v[184:187], v[160:163], v[36:39]
    v_add_u32 v206, s56, v204
    v_add_u32 v208, s56, v205
    v_xor_b32 v209, 32, v208
    s_waitcnt lgkmcnt(5)
    v_mfma_f32_16x16x32_bf16 v[8:11], v[188:191], v[164:167], v[8:11]
    s_waitcnt lgkmcnt(0)
    s_barrier
    v_mfma_f32_16x16x32_bf16 v[12:15], v[188:191], v[168:171], v[12:15]
    ds_read_b64_tr_b16 v[180:181], v208 offset:0
    ds_read_b64_tr_b16 v[182:183], v208 offset:2048
    v_mfma_f32_16x16x32_bf16 v[16:19], v[188:191], v[172:175], v[16:19]
    ds_read2st64_b64 v[148:151], v206 offset0:0 offset1:1
    v_mfma_f32_16x16x32_bf16 v[20:23], v[188:191], v[176:179], v[20:23]
    ds_read2st64_b64 v[152:155], v206 offset0:2 offset1:3
    v_mfma_f32_16x16x32_bf16 v[24:27], v[192:195], v[164:167], v[24:27]
    ds_read2st64_b64 v[156:159], v206 offset0:4 offset1:5
    v_mfma_f32_16x16x32_bf16 v[28:31], v[192:195], v[168:171], v[28:31]
    ds_read2st64_b64 v[160:163], v206 offset0:6 offset1:7
    v_mfma_f32_16x16x32_bf16 v[32:35], v[192:195], v[172:175], v[32:35]
    ds_read_b64_tr_b16 v[184:185], v209 offset:0
    v_mfma_f32_16x16x32_bf16 v[36:39], v[192:195], v[176:179], v[36:39]
    ds_read_b64_tr_b16 v[186:187], v209 offset:2048
    s_sub_u32 s58, s58, 1
    s_cmp_lg_u32 s58, 0
    s_cbranch_scc1 F_c4
    s_cmp_eq_u32 s63, 2
    s_cbranch_scc1 F_e4
    s_mov_b32 s63, 2
    s_mov_b32 s58, 1
    s_xor_b32 s64, s2, 4
    s_lshl_b32 s64, s64, 2
    s_add_u32 s64, s64, s5
    s_lshl_b32 s64, s64, 12
    s_add_u32 s64, s64, 28311552
    buffer_load_dwordx4 v[120:123], v1, s[24:27], s64 offen offset:0 sc1
    buffer_load_dwordx4 v[124:127], v1, s[24:27], s64 offen offset:1024 sc1
    buffer_load_dwordx4 v[128:131], v1, s[24:27], s64 offen offset:2048 sc1
    buffer_load_dwordx4 v[132:135], v1, s[24:27], s64 offen offset:3072 sc1
    s_mul_i32 s68, s5, 5120
    v_lshrrev_b32 v2, 4, v0
    v_lshl_add_u32 v2, v2, 3, s68
    v_mad_u32_u24 v4, v210, 40, 0
    v_lshl_add_u32 v4, v4, 1, v2
    v_xor_b32 v5, 4, v210
    v_mad_u32_u24 v5, v5, 40, 0
    v_lshl_add_u32 v5, v5, 1, v2
    v_lshrrev_b32 v2, 2, v0
    v_and_b32 v3, 3, v0
    v_lshlrev_b32 v3, 4, v3
    v_lshl_add_u32 v7, v2, 11, v3
    v_mad_u32_u24 v6, v2, 40, 0
    v_lshl_add_u32 v6, v6, 1, v3
    v_add_u32 v6, s68, v6
    s_lshl_b32 s66, s78, 1
    s_add_u32 s66, s66, s6
    s_lshl_b32 s66, s66, 17
    s_lshl_b32 s67, s79, 7
    s_add_u32 s66, s66, s67
    s_lshl_b32 s67, s7, 6
    s_add_u32 s66, s66, s67
    s_branch F_c4
F_e4:
    s_waitcnt vmcnt(0)
    v_max3_u32 v2, v120, v121, v122
    v_max3_u32 v2, v2, v123, v124
    v_max3_u32 v2, v2, v125, v126
    v_max3_u32 v2, v2, v127, v128
    v_max3_u32 v2, v2, v129, v130
    v_max3_u32 v2, v2, v131, v132
    v_max3_u32 v2, v2, v133, v134
    v_max_u32 v2, v2, v135
    v_cmp_eq_u32 vcc, -1, v2
    s_nop 4
    s_cbranch_vccz F_done26
    s_mov_b32 s69, 30000
F_poll26:
    buffer_load_dwordx4 v[120:123], v1, s[24:27], s64 offen offset:0 sc1
    buffer_load_dwordx4 v[124:127], v1, s[24:27], s64 offen offset:1024 sc1
    buffer_load_dwordx4 v[128:131], v1, s[24:27], s64 offen offset:2048 sc1
    buffer_load_dwordx4 v[132:135], v1, s[24:27], s64 offen offset:3072 sc1
    s_waitcnt vmcnt(0)
    v_max3_u32 v2, v120, v121, v122
    v_max3_u32 v2, v2, v123, v124
    v_max3_u32 v2, v2, v125, v126
    v_max3_u32 v2, v2, v127, v128
    v_max3_u32 v2, v2, v129, v130
    v_max3_u32 v2, v2, v131, v132
    v_max3_u32 v2, v2, v133, v134
    v_max_u32 v2, v2, v135
    v_cmp_eq_u32 vcc, -1, v2
    s_nop 4
    s_cbranch_vccz F_done26
    s_sleep 1
    s_sub_u32 s69, s69, 1
    s_cmp_lg_u32 s69, 0
    s_cbranch_scc1 F_poll26
F_done26:
    v_lshlrev_b32 v40, 16, v120
    v_and_b32 v41, 0xffff0000, v120
    v_lshlrev_b32 v42, 16, v121
    v_and_b32 v43, 0xffff0000, v121
    v_pk_add_f32 v[8:9], v[8:9], v[40:41]
    v_pk_add_f32 v[10:11], v[10:11], v[42:43]
    v_cvt_pk_bf16_f32 v88, v8, v9
    v_cvt_pk_bf16_f32 v89, v10, v11
    ds_write_b64 v4, v[88:89] offset:0
    v_lshlrev_b32 v56, 16, v128
    v_and_b32 v57, 0xffff0000, v128
    v_lshlrev_b32 v58, 16, v129
    v_and_b32 v59, 0xffff0000, v129
    v_pk_add_f32 v[24:25], v[24:25], v[56:57]
    v_pk_add_f32 v[26:27], v[26:27], v[58:59]
    v_cvt_pk_bf16_f32 v90, v24, v25
    v_cvt_pk_bf16_f32 v91, v26, v27
    ds_write_b64 v4, v[90:91] offset:32
    v_lshlrev_b32 v44, 16, v122
    v_and_b32 v45, 0xffff0000, v122
    v_lshlrev_b32 v46, 16, v123
    v_and_b32 v47, 0xffff0000, v123
    v_pk_add_f32 v[12:13], v[12:13], v[44:45]
    v_pk_add_f32 v[14:15], v[14:15], v[46:47]
    v_cvt_pk_bf16_f32 v92, v12, v13
    v_cvt_pk_bf16_f32 v93, v14, v15
    ds_write_b64 v5, v[92:93] offset:0
    v_lshlrev_b32 v60, 16, v130
    v_and_b32 v61, 0xffff0000, v130
    v_lshlrev_b32 v62, 16, v131
    v_and_b32 v63, 0xffff0000, v131
    v_pk_add_f32 v[28:29], v[28:29], v[60:61]
    v_pk_add_f32 v[30:31], v[30:31], v[62:63]
    v_cvt_pk_bf16_f32 v94, v28, v29
    v_cvt_pk_bf16_f32 v95, v30, v31
    ds_write_b64 v5, v[94:95] offset:32
    ds_read_b128 v[104:107], v6 offset:0
    ds_read_b128 v[108:111], v6 offset:1280
    v_lshlrev_b32 v48, 16, v124
    v_and_b32 v49, 0xffff0000, v124
    v_lshlrev_b32 v50, 16, v125
    v_and_b32 v51, 0xffff0000, v125
    v_pk_add_f32 v[16:17], v[16:17], v[48:49]
    v_pk_add_f32 v[18:19], v[18:19], v[50:51]
    v_cvt_pk_bf16_f32 v96, v16, v17
    v_cvt_pk_bf16_f32 v97, v18, v19
    ds_write_b64 v4, v[96:97] offset:2560
    v_lshlrev_b32 v64, 16, v132
    v_and_b32 v65, 0xffff0000, v132
    v_lshlrev_b32 v66, 16, v133
    v_and_b32 v67, 0xffff0000, v133
    v_pk_add_f32 v[32:33], v[32:33], v[64:65]
    v_pk_add_f32 v[34:35], v[34:35], v[66:67]
    v_cvt_pk_bf16_f32 v98, v32, v33
    v_cvt_pk_bf16_f32 v99, v34, v35
    ds_write_b64 v4, v[98:99] offset:2592
    v_lshlrev_b32 v52, 16, v126
    v_and_b32 v53, 0xffff0000, v126
    v_lshlrev_b32 v54, 16, v127
    v_and_b32 v55, 0xffff0000, v127
    v_pk_add_f32 v[20:21], v[20:21], v[52:53]
    v_pk_add_f32 v[22:23], v[22:23], v[54:55]
    v_cvt_pk_bf16_f32 v100, v20, v21
    v_cvt_pk_bf16_f32 v101, v22, v23
    ds_write_b64 v5, v[100:101] offset:2560
    v_lshlrev_b32 v68, 16, v134
    v_and_b32 v69, 0xffff0000, v134
    v_lshlrev_b32 v70, 16, v135
    v_and_b32 v71, 0xffff0000, v135
    v_pk_add_f32 v[36:37], v[36:37], v[68:69]
    v_pk_add_f32 v[38:39], v[38:39], v[70:71]
    v_cvt_pk_bf16_f32 v102, v36, v37
    v_cvt_pk_bf16_f32 v103, v38, v39
    ds_write_b64 v5, v[102:103] offset:2592
    ds_read_b128 v[112:115], v6 offset:2560
    ds_read_b128 v[116:119], v6 offset:3840
    s_waitcnt lgkmcnt(7)
    buffer_store_dwordx4 v[104:107], v7, s[48:51], s66 offen
    s_add_u32 s66, s66, 32768
    s_waitcnt lgkmcnt(6)
    buffer_store_dwordx4 v[108:111], v7, s[48:51], s66 offen
    s_add_u32 s66, s66, 32768
    s_waitcnt lgkmcnt(1)
    buffer_store_dwordx4 v[112:115], v7, s[48:51], s66 offen
    s_add_u32 s66, s66, 32768
    s_waitcnt lgkmcnt(0)
    buffer_store_dwordx4 v[116:119], v7, s[48:51], s66 offen
    s_add_u32 s66, s66, 32768
F_end:
F_exit:
    s_endpgm
.section .rodata,"a"
.p2align 6
.amdhsa_kernel gated_mix__grouped_kv_mqa__mixer_gmlp__prompt_kernel
  .amdhsa_next_free_vgpr 256
  .amdhsa_next_free_sgpr 102
  .amdhsa_accum_offset 256
  .amdhsa_group_segment_fixed_size 0
  .amdhsa_kernarg_size 112
  .amdhsa_user_sgpr_count 2
  .amdhsa_user_sgpr_kernarg_segment_ptr 1
  .amdhsa_system_sgpr_workgroup_id_x 1
  .amdhsa_float_denorm_mode_32 3
.end_amdhsa_kernel
```
